```python
import torch

def _softmax(x, axis=-1):
    return torch.softmax(x, dim=axis)
def _gelu(x):
    return torch.nn.functional.gelu(x, approximate="tanh")
def _silu(x):
    return torch.nn.functional.silu(x)
def _sigmoid(x):
    return torch.sigmoid(x)
def _layernorm(x, axis=-1, eps=1e-5):
    m = x.mean(dim=axis, keepdim=True)
    v = x.var(dim=axis, keepdim=True, unbiased=False)
    return (x - m) / torch.sqrt(v + eps)
def _scatter_add(tgt, idx, src, axis=0):
    return tgt.clone().index_add_(axis, idx, src)
def _segment_sum(src, seg, n):
    out = torch.zeros((n,) + src.shape[1:], dtype=src.dtype)
    return out.index_add_(0, seg, src)
def _pad(x, pw):
    flat = tuple(v for pair in reversed(pw) for v in pair)
    return torch.nn.functional.pad(x, flat)

kernel_name = 'interleave_layers__grouped_kv_mqa__moe_arch_mod__prompt'

def setup_inputs():

    _w = (lambda a: (lambda t: t.to(torch.bfloat16) if t.is_floating_point() else t)(torch.as_tensor(a)))
    def _A_setup():
        B, S, D, H = 1, 2048, 512, 32
        Dh = D // H
        return {
            "x": _w((lambda *s: torch.randn(*s, dtype=torch.bfloat16) * 0.05)(B, S, D)),
            "wq": _w((lambda *s: torch.randn(*s, dtype=torch.bfloat16) * 0.05)(D, H * Dh)),
            "wk": _w((lambda *s: torch.randn(*s, dtype=torch.bfloat16) * 0.05)(D, Dh)),
            "wv": _w((lambda *s: torch.randn(*s, dtype=torch.bfloat16) * 0.05)(D, Dh)),
            "wo": _w((lambda *s: torch.randn(*s, dtype=torch.bfloat16) * 0.05)(H * Dh, D)),
        }
    _A_in = _A_setup()

    def _B_setup():
        B, S, D, F, C = 1, 2048, 512, 1792, 1
        return {
            "x": _w((lambda *s: torch.randn(*s, dtype=torch.bfloat16) * 0.05)(B, S, D)),
            "w_r": _w((lambda *s: torch.randn(*s, dtype=torch.bfloat16) * 0.05)(D)),
            "w_gate": _w((lambda *s: torch.randn(*s, dtype=torch.bfloat16) * 0.05)(D, F)),
            "w_up": _w((lambda *s: torch.randn(*s, dtype=torch.bfloat16) * 0.05)(D, F)),
            "w_down": _w((lambda *s: torch.randn(*s, dtype=torch.bfloat16) * 0.05)(F, D)),
        }
    _B_in = _B_setup()

    return {
        "A_x": _A_in["x"],
        "A_wq": _A_in["wq"],
        "A_wk": _A_in["wk"],
        "A_wv": _A_in["wv"],
        "A_wo": _A_in["wo"],
        "B_x": _B_in["x"],
        "B_w_r": _B_in["w_r"],
        "B_w_gate": _B_in["w_gate"],
        "B_w_up": _B_in["w_up"],
        "B_w_down": _B_in["w_down"],
    }

def reference(A_x, A_wq, A_wk, A_wv, A_wo, B_x, B_w_r, B_w_gate, B_w_up, B_w_down):
    def _A_ref(x, wq, wk, wv, wo):
        B, S, D = x.shape
        H = 32
        Dh = D // H
        q = (lambda x, *d: x.permute(*d))((x @ wq).reshape(B, S, H, Dh), 0, 2, 1, 3)
        k = x @ wk
        v = x @ wv
        scores = torch.einsum("bhqd,bkd->bhqk", q, k) * (Dh ** -0.5)
        p = _softmax(scores, axis=-1)
        o = torch.einsum("bhqk,bkd->bhqd", p, v)
        return (lambda x, *d: x.permute(*d))(o, 0, 2, 1, 3).reshape(B, S, H * Dh) @ wo

    def _B_ref(x, w_r, w_gate, w_up, w_down):
        B, S, D = x.shape
        C = 1
        r = x @ w_r
        idx = torch.argsort(-r, axis=-1)[:, :C]
        idx_e = (lambda x, n, axis: torch.repeat_interleave(x, n, dim=axis))(idx.reshape(B, C, 1), D, axis=2)
        x_sel = (lambda x, i, axis: torch.take_along_dim(x, i, dim=axis))(x, idx_e, axis=1)
        g = _silu(x_sel @ w_gate)
        u = x_sel @ w_up
        y = (g * u) @ w_down
        r_sel = _sigmoid((lambda x, i, axis: torch.take_along_dim(x, i, dim=axis))(r, idx, axis=1))
        y = y * r_sel.reshape(B, C, 1)
        b_off = (torch.arange(B) * S).reshape(B, 1)
        flat_idx = (idx + b_off).reshape(B * C)
        zero = (x * 0.0).reshape(B * S, D)
        upd = _scatter_add(zero, flat_idx, y.reshape(B * C, D), axis=0)
        return x + upd.reshape(B, S, D)

    x = A_x
    x = x + _A_ref(_layernorm(x, axis=-1), A_wq, A_wk, A_wv, A_wo)
    x = x + _B_ref(_layernorm(x, axis=-1), B_w_r, B_w_gate, B_w_up, B_w_down)
    x = x + _A_ref(_layernorm(x, axis=-1), A_wq, A_wk, A_wv, A_wo)
    x = x + _B_ref(_layernorm(x, axis=-1), B_w_r, B_w_gate, B_w_up, B_w_down)
    return x
```

```asm
; @launch grid=(256,1,1) block=(512,1,1) lds=162816
.amdgcn_target "amdgcn-amd-amdhsa--gfx950"
.text
.globl interleave_layers__grouped_kv_mqa__moe_arch_mod__prompt_kernel
.p2align 8
.type interleave_layers__grouped_kv_mqa__moe_arch_mod__prompt_kernel,@function
interleave_layers__grouped_kv_mqa__moe_arch_mod__prompt_kernel:
    s_cmp_ge_u32 s2, 256
    s_cbranch_scc1 L_end_1
    v_lshrrev_b32 v1, 6, v0
    v_and_b32 v0, 63, v0
    v_readfirstlane_b32 s3, v1
    v_lshlrev_b32 v1, 4, v0
    s_cmp_lg_u32 s3, 7
    s_cbranch_scc1 L_e0_4
    s_getpc_b64 s[4:5]
    s_lshr_b32 s10, s2, 3
    s_lshl_b32 s10, s10, 10
    v_lshlrev_b32 v2, 7, v0
    v_add_u32 v2, s10, v2
    s_mov_b64 exec, 0xff
    global_load_dword v250, v2, s[4:5]
    s_mov_b64 exec, -1
    v_mov_b32 v4, 0
    v_lshlrev_b32 v5, 2, v0
    v_mul_u32_u24 v6, 1040, v0
    s_mov_b64 exec, 0xffffffff
    ds_write_b32 v5, v4 offset:10496
    s_mov_b64 exec, 0x1ff
    ds_write_b32 v6, v4 offset:1024
    s_mov_b64 exec, -1
    s_waitcnt lgkmcnt(0)
L_e0_4:
    s_load_dwordx16 s[16:31], s[0:1], 0
    s_load_dwordx8 s[32:39], s[0:1], 64
    s_load_dwordx2 s[40:41], s[0:1], 96
    s_barrier
    s_mov_b32 s7, 0
    s_mov_b32 s14, 16777216
    s_mov_b32 s15, 0
    s_mov_b32 s95, 0x3f803f80
    s_lshl_b32 s6, s2, 3
    s_add_u32 s6, s6, s3
    s_and_b32 s4, s2, 7
    s_lshr_b32 s5, s2, 3
    s_mul_i32 s10, s4, 28
    s_add_u32 s10, s10, s5
    s_lshl_b32 s11, s4, 2
    s_add_u32 s11, s11, s5
    s_sub_u32 s11, s11, 28
    s_cmp_ge_u32 s2, 224
    s_cselect_b32 s43, s11, s10
    s_cselect_b32 s96, 1, 0
    v_mov_b32 v15, 0
    s_cmp_ge_u32 s3, 4
    s_cbranch_scc1 L_hstart_3
    s_setprio 3
    v_lshrrev_b32 v3, 5, v0
    v_and_b32 v2, 31, v0
    v_lshlrev_b32 v2, 4, v2
    v_mul_u32_u24 v8, 1056, v3
    v_add_u32 v8, v8, v2
    v_lshl_add_u32 v2, v3, 10, v2
    s_add_u32 s8, s6, s3
    s_lshl_b32 s8, s8, 10
    s_mov_b32 s50, 2097152
    s_mov_b32 s51, 0x00020000
    s_mul_i32 s4, s3, 2112
    v_add_u32 v8, s4, v8
    v_mov_b32 v9, 0
    v_mov_b32 v10, 1
    v_mov_b32 v4, 0
    v_mov_b32 v5, 0
    v_mov_b32 v6, 0
    v_mov_b32 v7, 0
    s_waitcnt lgkmcnt(0)
    s_mov_b32 s48, s16
    s_mov_b32 s49, s17
    buffer_load_dwordx4 v[16:19], v2, s[48:51], s8 offen
    buffer_load_dwordx4 v[20:23], v2, s[48:51], s8 offen offset:512
    s_mov_b32 s44, s40
    s_mov_b32 s45, s41
    s_mov_b32 s46, 0x400000
    s_mov_b32 s47, 0x00020000
    s_cmp_lg_u32 s6, 0
    s_cbranch_scc1 L_cz_13
    s_mov_b32 s4, 0x260000
    buffer_store_dwordx4 v[4:7], v1, s[44:47], s4 offen offset:0 sc1
    buffer_store_dwordx4 v[4:7], v1, s[44:47], s4 offen offset:1024 sc1
    buffer_store_dwordx4 v[4:7], v1, s[44:47], s4 offen offset:2048 sc1
    buffer_store_dwordx4 v[4:7], v1, s[44:47], s4 offen offset:3072 sc1
    s_add_u32 s4, s4, 4096
    buffer_store_dwordx4 v[4:7], v1, s[44:47], s4 offen offset:0 sc1
    buffer_store_dwordx4 v[4:7], v1, s[44:47], s4 offen offset:1024 sc1
    buffer_store_dwordx4 v[4:7], v1, s[44:47], s4 offen offset:2048 sc1
    buffer_store_dwordx4 v[4:7], v1, s[44:47], s4 offen offset:3072 sc1
    s_add_u32 s4, s4, 4096
    buffer_store_dwordx4 v[4:7], v1, s[44:47], s4 offen offset:0 sc1
    buffer_store_dwordx4 v[4:7], v1, s[44:47], s4 offen offset:1024 sc1
    buffer_store_dwordx4 v[4:7], v1, s[44:47], s4 offen offset:2048 sc1
    buffer_store_dwordx4 v[4:7], v1, s[44:47], s4 offen offset:3072 sc1
    s_add_u32 s4, s4, 4096
    buffer_store_dwordx4 v[4:7], v1, s[44:47], s4 offen offset:0 sc1
    buffer_store_dwordx4 v[4:7], v1, s[44:47], s4 offen offset:1024 sc1
    buffer_store_dwordx4 v[4:7], v1, s[44:47], s4 offen offset:2048 sc1
    buffer_store_dwordx4 v[4:7], v1, s[44:47], s4 offen offset:3072 sc1
    s_add_u32 s4, s4, 4096
L_cz_13:
    s_mov_b32 s52, s36
    s_mov_b32 s53, s37
    s_mov_b32 s54, 0x200000
    s_mov_b32 s55, 0x00020000
    s_mov_b32 s60, s28
    s_mov_b32 s61, s29
    s_mov_b32 s62, 0x400
    s_mov_b32 s63, 0x00020000
    s_mov_b32 s72, s38
    s_mov_b32 s73, s39
    s_mov_b32 s74, 0x100
    s_mov_b32 s75, 0x00020000
    s_mov_b32 s48, s34
    s_mov_b32 s49, s35
    s_mov_b32 s50, 0x1c0000
    s_mov_b32 s51, 0x00020000
    s_cmp_eq_u32 s3, 6
    s_cselect_b32 s56, s30, s32
    s_cselect_b32 s57, s31, s33
    s_mov_b32 s58, 1835008
    s_mov_b32 s59, 0x00020000
    s_cmp_lt_u32 s3, 6
    s_cselect_b32 s64, s30, s32
    s_cselect_b32 s65, s31, s33
    s_cmp_ge_u32 s2, 224
    s_cselect_b32 s64, s34, s64
    s_cselect_b32 s65, s35, s65
    s_mov_b32 s66, 1835008
    s_mov_b32 s67, 0x00020000
    s_mov_b32 s68, s18
    s_mov_b32 s69, s19
    s_mov_b32 s70, 0x80000
    s_mov_b32 s71, 0x00020000
    v_lshrrev_b32 v12, 3, v0
    v_lshlrev_b32 v12, 10, v12
    v_and_b32 v13, 7, v0
    v_lshl_add_u32 v12, v13, 4, v12
    v_and_b32 v13, 32, v0
    v_xor_b32 v12, v12, v13
    v_xor_b32 v13, 64, v12
    s_waitcnt vmcnt(0)
    s_cmp_lg_u32 s6, 0
    s_cbranch_scc1 L_cz2_14
    s_mov_b64 exec, 1
    buffer_store_dword v10, off, s[72:75], 0 sc1
    s_mov_b64 exec, -1
L_cz2_14:
    v_dot2_f32_bf16 v60, v16, s95, 0
    v_dot2_f32_bf16 v61, v16, v16, 0
    v_dot2_f32_bf16 v60, v17, s95, v60
    v_dot2_f32_bf16 v61, v17, v17, v61
    v_dot2_f32_bf16 v60, v18, s95, v60
    v_dot2_f32_bf16 v61, v18, v18, v61
    v_dot2_f32_bf16 v60, v19, s95, v60
    v_dot2_f32_bf16 v61, v19, v19, v61
    v_dot2_f32_bf16 v60, v20, s95, v60
    v_dot2_f32_bf16 v61, v20, v20, v61
    v_dot2_f32_bf16 v60, v21, s95, v60
    v_dot2_f32_bf16 v61, v21, v21, v61
    v_dot2_f32_bf16 v60, v22, s95, v60
    v_dot2_f32_bf16 v61, v22, v22, v61
    v_dot2_f32_bf16 v60, v23, s95, v60
    v_dot2_f32_bf16 v61, v23, v23, v61
    v_lshlrev_b32 v32, 16, v16
    v_and_b32 v33, 0xffff0000, v16
    v_lshlrev_b32 v34, 16, v17
    v_add_f32_dpp v60, v60, v60 quad_perm:[1,0,3,2] row_mask:0xf bank_mask:0xf
    v_add_f32_dpp v61, v61, v61 quad_perm:[1,0,3,2] row_mask:0xf bank_mask:0xf
    v_and_b32 v35, 0xffff0000, v17
    v_add_f32_dpp v60, v60, v60 quad_perm:[2,3,0,1] row_mask:0xf bank_mask:0xf
    v_add_f32_dpp v61, v61, v61 quad_perm:[2,3,0,1] row_mask:0xf bank_mask:0xf
    v_lshlrev_b32 v36, 16, v18
    v_add_f32_dpp v60, v60, v60 row_half_mirror row_mask:0xf bank_mask:0xf
    v_add_f32_dpp v61, v61, v61 row_half_mirror row_mask:0xf bank_mask:0xf
    v_and_b32 v37, 0xffff0000, v18
    v_add_f32_dpp v60, v60, v60 row_mirror row_mask:0xf bank_mask:0xf
    v_add_f32_dpp v61, v61, v61 row_mirror row_mask:0xf bank_mask:0xf
    v_mov_b32 v62, v60
    v_mov_b32 v63, v61
    v_lshlrev_b32 v38, 16, v19
    v_permlane16_swap_b32 v60, v62
    v_permlane16_swap_b32 v61, v63
    v_add_f32 v60, v60, v62
    v_add_f32 v61, v61, v63
    v_and_b32 v39, 0xffff0000, v19
    v_lshlrev_b32 v40, 16, v20
    v_and_b32 v41, 0xffff0000, v20
    v_lshlrev_b32 v42, 16, v21
    v_and_b32 v43, 0xffff0000, v21
    v_lshlrev_b32 v44, 16, v22
    v_and_b32 v45, 0xffff0000, v22
    v_lshlrev_b32 v46, 16, v23
    v_and_b32 v47, 0xffff0000, v23
    v_mul_f32 v58, 0x3b000000, v60
    v_mul_f32 v56, 0x3b000000, v61
    v_fma_f32 v56, -v58, v58, v56
    v_max_f32 v56, 0, v56
    v_cvt_pk_bf16_f32 v57, v58, v56
    v_and_b32 v56, 0xffff0000, v57
    v_add_f32 v56, 0x3727c5ac, v56
    v_cvt_pk_bf16_f32 v56, v56, v56
    v_lshlrev_b32 v56, 16, v56
    v_sqrt_f32 v56, v56
    v_lshlrev_b32 v58, 16, v57
    v_cvt_pk_bf16_f32 v56, v56, v56
    v_lshlrev_b32 v56, 16, v56
    v_rcp_f32 v56, v56
    v_sub_f32 v59, 0, v58
    v_mul_f32 v58, -v58, v56
    v_pk_add_f32 v[32:33], v[32:33], v[58:59] op_sel:[0,1] op_sel_hi:[1,1]
    v_pk_add_f32 v[34:35], v[34:35], v[58:59] op_sel:[0,1] op_sel_hi:[1,1]
    v_pk_add_f32 v[36:37], v[36:37], v[58:59] op_sel:[0,1] op_sel_hi:[1,1]
    v_pk_add_f32 v[38:39], v[38:39], v[58:59] op_sel:[0,1] op_sel_hi:[1,1]
    v_cvt_pk_bf16_f32 v24, v32, v33
    v_cvt_pk_bf16_f32 v25, v34, v35
    v_cvt_pk_bf16_f32 v26, v36, v37
    v_cvt_pk_bf16_f32 v27, v38, v39
    v_lshlrev_b32 v32, 16, v24
    v_and_b32 v33, 0xffff0000, v24
    v_lshlrev_b32 v34, 16, v25
    v_and_b32 v35, 0xffff0000, v25
    v_lshlrev_b32 v36, 16, v26
    v_and_b32 v37, 0xffff0000, v26
    v_lshlrev_b32 v38, 16, v27
    v_and_b32 v39, 0xffff0000, v27
    v_pk_mul_f32 v[32:33], v[32:33], v[56:57] op_sel_hi:[1,0]
    v_pk_mul_f32 v[34:35], v[34:35], v[56:57] op_sel_hi:[1,0]
    v_pk_mul_f32 v[36:37], v[36:37], v[56:57] op_sel_hi:[1,0]
    v_pk_mul_f32 v[38:39], v[38:39], v[56:57] op_sel_hi:[1,0]
    v_cvt_pk_bf16_f32 v24, v32, v33
    v_cvt_pk_bf16_f32 v25, v34, v35
    v_cvt_pk_bf16_f32 v26, v36, v37
    v_cvt_pk_bf16_f32 v27, v38, v39
    v_pk_add_f32 v[40:41], v[40:41], v[58:59] op_sel:[0,1] op_sel_hi:[1,1]
    v_pk_add_f32 v[42:43], v[42:43], v[58:59] op_sel:[0,1] op_sel_hi:[1,1]
    v_pk_add_f32 v[44:45], v[44:45], v[58:59] op_sel:[0,1] op_sel_hi:[1,1]
    v_pk_add_f32 v[46:47], v[46:47], v[58:59] op_sel:[0,1] op_sel_hi:[1,1]
    v_cvt_pk_bf16_f32 v28, v40, v41
    v_cvt_pk_bf16_f32 v29, v42, v43
    v_cvt_pk_bf16_f32 v30, v44, v45
    v_cvt_pk_bf16_f32 v31, v46, v47
    v_lshlrev_b32 v40, 16, v28
    v_and_b32 v41, 0xffff0000, v28
    v_lshlrev_b32 v42, 16, v29
    v_and_b32 v43, 0xffff0000, v29
    v_lshlrev_b32 v44, 16, v30
    v_and_b32 v45, 0xffff0000, v30
    v_lshlrev_b32 v46, 16, v31
    v_and_b32 v47, 0xffff0000, v31
    v_pk_mul_f32 v[40:41], v[40:41], v[56:57] op_sel_hi:[1,0]
    v_pk_mul_f32 v[42:43], v[42:43], v[56:57] op_sel_hi:[1,0]
    v_pk_mul_f32 v[44:45], v[44:45], v[56:57] op_sel_hi:[1,0]
    v_pk_mul_f32 v[46:47], v[46:47], v[56:57] op_sel_hi:[1,0]
    v_cvt_pk_bf16_f32 v28, v40, v41
    v_cvt_pk_bf16_f32 v29, v42, v43
    v_cvt_pk_bf16_f32 v30, v44, v45
    v_cvt_pk_bf16_f32 v31, v46, v47
    ds_write_b128 v8, v[24:27] offset:12288
    ds_write_b128 v8, v[28:31] offset:12800
    s_mov_b64 exec, 1
    ds_add_u32 v9, v10 offset:10588
    s_mov_b64 exec, -1
    ds_write_b128 v8, v[16:19] offset:20736
    ds_write_b128 v8, v[20:23] offset:21248
    s_setprio 0
    s_lshl_b32 s5, s3, 14
    s_add_u32 s5, s5, 63488
    s_lshl_b32 s4, s3, 17
    s_mov_b32 s10, 8
L_rawl_23:
    s_mov_b32 m0, s5
    s_add_u32 s5, s5, 1024
    buffer_load_dwordx4 v12, s[68:71], s4 offen lds
    s_add_u32 s4, s4, 0x2000
    s_mov_b32 m0, s5
    s_add_u32 s5, s5, 1024
    buffer_load_dwordx4 v13, s[68:71], s4 offen lds
    s_add_u32 s4, s4, 0x2000
    s_sub_u32 s10, s10, 1
    s_cmp_lg_u32 s10, 0
    s_cbranch_scc1 L_rawl_23
    s_waitcnt vmcnt(0)
    s_mov_b64 exec, 1
    ds_add_u32 v9, v10 offset:10580
    s_mov_b64 exec, -1
    v_mov_b32 v7, v0
    v_mov_b32 v0, 0
    s_mov_b64 s[32:33], 0
    s_mov_b64 s[34:35], 0
    s_mov_b32 s40, 0
    s_mov_b32 s13, 4
    s_branch L_patch_24
L_patchret_25:
    v_mov_b32 v0, v7
L_ctop_15:
    v_and_b32 v4, 15, v0
    v_cmp_eq_u32 vcc, 0, v4
    v_lshlrev_b32 v1, 4, v0
    v_lshlrev_b32 v6, 6, v0
    v_mov_b32 v5, s95
    v_cndmask_b32 v3, 0, v5, vcc
    v_lshlrev_b32 v4, 4, v4
    v_bfe_u32 v5, v0, 4, 1
    v_lshl_add_u32 v4, v5, 9, v4
    v_bfe_u32 v5, v0, 5, 1
    v_lshl_add_u32 v4, v5, 8, v4
    v_mov_b32 v132, v3
    v_mov_b32 v133, v3
    v_mov_b32 v134, v3
    v_mov_b32 v135, v3
    v_mov_b32 v140, v3
    v_mov_b32 v141, v3
    v_mov_b32 v142, v3
    v_mov_b32 v143, v3
    v_mov_b32 v148, v3
    v_mov_b32 v149, v3
    v_mov_b32 v150, v3
    v_mov_b32 v151, v3
    v_mov_b32 v156, v3
    v_mov_b32 v157, v3
    v_mov_b32 v158, v3
    v_mov_b32 v159, v3
    v_mov_b32 v164, v3
    v_mov_b32 v165, v3
    v_mov_b32 v166, v3
    v_mov_b32 v167, v3
    v_mov_b32 v172, v3
    v_mov_b32 v173, v3
    v_mov_b32 v174, v3
    v_mov_b32 v175, v3
    v_mov_b32 v180, v3
    v_mov_b32 v181, v3
    v_mov_b32 v182, v3
    v_mov_b32 v183, v3
    v_mov_b32 v188, v3
    v_mov_b32 v189, v3
    v_mov_b32 v190, v3
    v_mov_b32 v191, v3
    v_mov_b32 v196, v3
    v_mov_b32 v197, v3
    v_mov_b32 v198, v3
    v_mov_b32 v199, v3
    v_mov_b32 v204, v3
    v_mov_b32 v205, v3
    v_mov_b32 v206, v3
    v_mov_b32 v207, v3
    v_mov_b32 v212, v3
    v_mov_b32 v213, v3
    v_mov_b32 v214, v3
    v_mov_b32 v215, v3
    v_mov_b32 v220, v3
    v_mov_b32 v221, v3
    v_mov_b32 v222, v3
    v_mov_b32 v223, v3
    v_mov_b32 v228, v3
    v_mov_b32 v229, v3
    v_mov_b32 v230, v3
    v_mov_b32 v231, v3
    v_mov_b32 v236, v3
    v_mov_b32 v237, v3
    v_mov_b32 v238, v3
    v_mov_b32 v239, v3
    v_mov_b32 v244, v3
    v_mov_b32 v245, v3
    v_mov_b32 v246, v3
    v_mov_b32 v247, v3
    v_mov_b32 v252, v3
    v_mov_b32 v253, v3
    v_mov_b32 v254, v3
    v_mov_b32 v255, v3
    s_lshl_b32 s10, s3, 12
    s_add_u32 s10, s10, 0x260000
    s_lshl_b32 s4, s15, 17
    s_sub_u32 s10, s10, s4
    s_lshl_b32 s8, s3, 14
    s_add_u32 s8, s8, s4
    s_add_u32 s8, s8, 0x100000
    s_bfe_u32 s9, s2, 0x40003
    s_lshl_b32 s9, s9, 10
    s_mov_b32 s13, 4
    v_add_u32 v4, 0x10000, v4
    s_mul_i32 s11, s3, 2304
    s_add_u32 s11, s11, 45056
    v_mov_b32 v3, 0
    v_mov_b32 v5, v1
    v_mov_b32 v7, v0
    v_mov_b32 v2, 0xdddd
    s_cmp_lg_u32 s15, 0
    s_cbranch_scc1 L_cg1_18
    v_mov_b32 v48, 0
L_lw_26:
    s_sub_u32 s14, s14, 1
    s_cbranch_scc1 L_end_1
    s_sleep 1
    ds_read_b32 v49, v48 offset:10564
    s_waitcnt lgkmcnt(0)
    v_cmp_ne_u32 vcc, 5, v49
    s_cbranch_vccnz L_lw_26
    s_setprio 3
    s_mov_b64 vcc, -1
L_fp_27:
    s_sub_u32 s14, s14, 1
    s_cbranch_scc1 L_end_1
    s_mov_b64 exec, vcc
    s_sleep 14
L_fp_27x:
    buffer_load_dword v48, v6, s[44:47], s10 offen offset:0 sc1
    s_waitcnt vmcnt(0)
    v_cmp_eq_u32 vcc, 0, v48
    s_cbranch_vccnz L_fp_27
    s_mov_b64 exec, -1
    s_branch L_cg0_17
L_cg1_18:
    v_mov_b32 v48, 0
L_lw_28:
    s_sub_u32 s14, s14, 1
    s_cbranch_scc1 L_end_1
    s_sleep 1
    ds_read_b32 v49, v48 offset:10572
    s_waitcnt lgkmcnt(0)
    v_cmp_eq_u32 vcc, 0, v49
    s_cbranch_vccnz L_lw_28
    v_readfirstlane_b32 s4, v49
    s_and_b32 s4, s4, 0x7ff
    s_sub_u32 s4, 2047, s4
    s_lshr_b32 s5, s4, 9
    s_cmp_lg_u32 s5, s3
    s_cbranch_scc1 L_cg1_18y
    s_mov_b32 s13, 99
    s_bfe_u32 s9, s4, 0x40005
    s_add_u32 s9, s9, 1
    s_and_b32 s9, s9, 15
    s_lshl_b32 s9, s9, 10
    s_and_b32 s5, s4, 31
    s_lshl_b32 s32, 1, s5
    s_mov_b32 s33, s32
    s_bfe_u32 s5, s4, 0x10003
    s_lshl_b32 s5, s5, 5
    s_bfm_b64 s[34:35], 16, s5
    s_and_b32 s5, s4, 1
    s_lshl_b32 s5, s5, 4
    s_lshl_b32 s41, 0xffff, s5
    s_bfe_u32 s5, s4, 0x10004
    s_bfe_u32 s4, s4, 0x20001
    s_lshl_b32 s5, s5, 2
    s_add_u32 s4, s4, s5
    s_mov_b32 s40, 2
    s_cmp_eq_u32 s4, 0
    s_cselect_b32 s36, s41, 0
    s_cmp_eq_u32 s4, 1
    s_cselect_b32 s37, s41, 0
    s_cmp_eq_u32 s4, 2
    s_cselect_b32 s38, s41, 0
    s_cmp_eq_u32 s4, 3
    s_cselect_b32 s39, s41, 0
    s_cmp_eq_u32 s4, 4
    s_cselect_b32 s98, s41, 0
    s_cmp_eq_u32 s4, 5
    s_cselect_b32 s99, s41, 0
    s_cmp_eq_u32 s4, 6
    s_cselect_b32 s100, s41, 0
    s_cmp_eq_u32 s4, 7
    s_cselect_b32 s101, s41, 0
L_cg1_18y:
L_cg0_17:
    s_mov_b32 s10, s9
    s_add_u32 s4, s8, s9
    buffer_load_dwordx4 v[64:67], v5, s[44:47], s4 offen sc1
    buffer_load_dwordx4 v[128:131], v4, s[44:47], s4 offen sc1
    s_add_u32 s9, s9, 1024
    s_and_b32 s9, s9, 0x3fff
    s_add_u32 s4, s8, s9
    buffer_load_dwordx4 v[68:71], v5, s[44:47], s4 offen sc1
    buffer_load_dwordx4 v[136:139], v4, s[44:47], s4 offen sc1
    s_add_u32 s9, s9, 1024
    s_and_b32 s9, s9, 0x3fff
    s_add_u32 s4, s8, s9
    buffer_load_dwordx4 v[72:75], v5, s[44:47], s4 offen sc1
    buffer_load_dwordx4 v[144:147], v4, s[44:47], s4 offen sc1
    s_add_u32 s9, s9, 1024
    s_and_b32 s9, s9, 0x3fff
    s_add_u32 s4, s8, s9
    buffer_load_dwordx4 v[76:79], v5, s[44:47], s4 offen sc1
    buffer_load_dwordx4 v[152:155], v4, s[44:47], s4 offen sc1
    s_add_u32 s9, s9, 1024
    s_and_b32 s9, s9, 0x3fff
    s_add_u32 s4, s8, s9
    buffer_load_dwordx4 v[80:83], v5, s[44:47], s4 offen sc1
    buffer_load_dwordx4 v[160:163], v4, s[44:47], s4 offen sc1
    s_add_u32 s9, s9, 1024
    s_and_b32 s9, s9, 0x3fff
    s_add_u32 s4, s8, s9
    buffer_load_dwordx4 v[84:87], v5, s[44:47], s4 offen sc1
    buffer_load_dwordx4 v[168:171], v4, s[44:47], s4 offen sc1
    s_add_u32 s9, s9, 1024
    s_and_b32 s9, s9, 0x3fff
    s_add_u32 s4, s8, s9
    buffer_load_dwordx4 v[88:91], v5, s[44:47], s4 offen sc1
    buffer_load_dwordx4 v[176:179], v4, s[44:47], s4 offen sc1
    s_add_u32 s9, s9, 1024
    s_and_b32 s9, s9, 0x3fff
    s_add_u32 s4, s8, s9
    buffer_load_dwordx4 v[92:95], v5, s[44:47], s4 offen sc1
    buffer_load_dwordx4 v[184:187], v4, s[44:47], s4 offen sc1
    s_add_u32 s9, s9, 1024
    s_and_b32 s9, s9, 0x3fff
    s_setprio 0
    s_mov_b32 m0, s11
    v_mov_b32 v0, 0
    v_mov_b32 v1, 0
    ds_read_b32 v6, v3 offset:1024
    ds_read_b128 v[8:11], v5 offset:0
    s_waitcnt lgkmcnt(0)
    v_cmp_ne_u32 vcc, 4, v6
    s_cbranch_vccnz L_upfront_29
    s_waitcnt vmcnt(14)
L_kvc_31:
    v_max3_u32 v12, v64, v65, v66
    v_max3_u32 v13, v128, v129, v130
    v_max3_u32 v12, v67, v131, v12
    v_max_u32 v12, v12, v13
    v_cmp_eq_u32 vcc, -1, v12
    s_cbranch_vccnz L_kvs_32
    v_permlane16_swap_b32 v128, v132
    v_permlane16_swap_b32 v129, v133
    v_permlane16_swap_b32 v130, v134
    v_permlane16_swap_b32 v131, v135
    v_mfma_f32_32x32x16_bf16 v[32:47], v[64:67], v[8:11], 0
    s_mov_b32 s12, 3
    s_waitcnt vmcnt(12)
L_kvc_33:
    v_max3_u32 v12, v68, v69, v70
    v_max3_u32 v13, v136, v137, v138
    v_max3_u32 v12, v71, v139, v12
    v_max_u32 v12, v12, v13
    v_cmp_eq_u32 vcc, -1, v12
    s_cbranch_vccnz L_kvs_34
    v_permlane16_swap_b32 v136, v140
    v_permlane16_swap_b32 v137, v141
    v_permlane16_swap_b32 v138, v142
    v_permlane16_swap_b32 v139, v143
    s_setprio 3
    s_add_u32 s4, s8, s9
    buffer_load_dwordx4 v[96:99], v5, s[44:47], s4 offen sc1
    buffer_load_dwordx4 v[192:195], v4, s[44:47], s4 offen sc1
    s_add_u32 s9, s9, 1024
    s_and_b32 s9, s9, 0x3fff
    s_add_u32 s4, s8, s9
    buffer_load_dwordx4 v[100:103], v5, s[44:47], s4 offen sc1
    buffer_load_dwordx4 v[200:203], v4, s[44:47], s4 offen sc1
    s_add_u32 s9, s9, 1024
    s_and_b32 s9, s9, 0x3fff
    s_setprio 0
    s_waitcnt vmcnt(14)
L_kvc_35:
    v_max3_u32 v12, v72, v73, v74
    v_max3_u32 v13, v144, v145, v146
    v_max3_u32 v12, v75, v147, v12
    v_max_u32 v12, v12, v13
    v_cmp_eq_u32 vcc, -1, v12
    s_cbranch_vccnz L_kvs_36
    v_permlane16_swap_b32 v144, v148
    v_permlane16_swap_b32 v145, v149
    v_permlane16_swap_b32 v146, v150
    v_permlane16_swap_b32 v147, v151
    s_waitcnt vmcnt(12)
L_kvc_37:
    v_max3_u32 v12, v76, v77, v78
    v_max3_u32 v13, v152, v153, v154
    v_max3_u32 v12, v79, v155, v12
    v_max_u32 v12, v12, v13
    v_cmp_eq_u32 vcc, -1, v12
    s_cbranch_vccnz L_kvs_38
    v_permlane16_swap_b32 v152, v156
    v_permlane16_swap_b32 v153, v157
    v_permlane16_swap_b32 v154, v158
    v_permlane16_swap_b32 v155, v159
    v_exp_f32 v32, v32
    v_exp_f32 v33, v33
    v_exp_f32 v34, v34
    v_exp_f32 v35, v35
    v_exp_f32 v36, v36
    v_mfma_f32_32x32x16_bf16 v[48:63], v[68:71], v[8:11], 0
    v_exp_f32 v37, v37
    v_exp_f32 v38, v38
    v_exp_f32 v39, v39
    v_exp_f32 v40, v40
    v_exp_f32 v41, v41
    v_exp_f32 v42, v42
    v_exp_f32 v43, v43
    v_exp_f32 v44, v44
    v_mfma_f32_32x32x8_bf16 v[16:31], v[0:1], v[0:1], 0
    v_exp_f32 v45, v45
    v_exp_f32 v46, v46
    v_exp_f32 v47, v47
    s_setprio 3
    s_add_u32 s4, s8, s9
    buffer_load_dwordx4 v[104:107], v5, s[44:47], s4 offen sc1
    buffer_load_dwordx4 v[208:211], v4, s[44:47], s4 offen sc1
    s_add_u32 s9, s9, 1024
    s_and_b32 s9, s9, 0x3fff
    s_add_u32 s4, s8, s9
    buffer_load_dwordx4 v[108:111], v5, s[44:47], s4 offen sc1
    buffer_load_dwordx4 v[216:219], v4, s[44:47], s4 offen sc1
    s_add_u32 s9, s9, 1024
    s_and_b32 s9, s9, 0x3fff
    s_setprio 0
    s_waitcnt vmcnt(14)
L_kvc_39:
    v_max3_u32 v12, v80, v81, v82
    v_max3_u32 v13, v160, v161, v162
    v_max3_u32 v12, v83, v163, v12
    v_max_u32 v12, v12, v13
    v_cmp_eq_u32 vcc, -1, v12
    s_cbranch_vccnz L_kvs_40
    v_permlane16_swap_b32 v160, v164
    v_permlane16_swap_b32 v161, v165
    v_permlane16_swap_b32 v162, v166
    v_permlane16_swap_b32 v163, v167
    s_waitcnt vmcnt(12)
L_kvc_41:
    v_max3_u32 v12, v84, v85, v86
    v_max3_u32 v13, v168, v169, v170
    v_max3_u32 v12, v87, v171, v12
    v_max_u32 v12, v12, v13
    v_cmp_eq_u32 vcc, -1, v12
    s_cbranch_vccnz L_kvs_42
    v_permlane16_swap_b32 v168, v172
    v_permlane16_swap_b32 v169, v173
    v_permlane16_swap_b32 v170, v174
    v_permlane16_swap_b32 v171, v175
    v_smfmac_f32_32x32x32_bf16 v[16:31], v[128:131], v[32:39], v2
    v_exp_f32 v48, v48
    v_exp_f32 v49, v49
    v_exp_f32 v50, v50
    v_smfmac_f32_32x32x32_bf16 v[16:31], v[132:135], v[40:47], v2
    v_exp_f32 v51, v51
    v_exp_f32 v52, v52
    v_exp_f32 v53, v53
    v_mfma_f32_32x32x16_bf16 v[32:47], v[72:75], v[8:11], 0
    v_exp_f32 v54, v54
    v_exp_f32 v55, v55
    v_exp_f32 v56, v56
    v_exp_f32 v57, v57
    v_smfmac_f32_32x32x32_bf16 v[16:31], v[136:139], v[48:55], v2
    v_exp_f32 v58, v58
    v_exp_f32 v59, v59
    v_exp_f32 v60, v60
    v_exp_f32 v61, v61
    v_exp_f32 v62, v62
    v_exp_f32 v63, v63
    s_nop 0
    s_setprio 3
    s_add_u32 s4, s8, s9
    buffer_load_dwordx4 v[112:115], v5, s[44:47], s4 offen sc1
    buffer_load_dwordx4 v[224:227], v4, s[44:47], s4 offen sc1
    s_add_u32 s9, s9, 1024
    s_and_b32 s9, s9, 0x3fff
    s_add_u32 s4, s8, s9
    buffer_load_dwordx4 v[116:119], v5, s[44:47], s4 offen sc1
    buffer_load_dwordx4 v[232:235], v4, s[44:47], s4 offen sc1
    s_add_u32 s9, s9, 1024
    s_and_b32 s9, s9, 0x3fff
    s_setprio 0
    s_waitcnt vmcnt(14)
L_kvc_43:
    v_max3_u32 v12, v88, v89, v90
    v_max3_u32 v13, v176, v177, v178
    v_max3_u32 v12, v91, v179, v12
    v_max_u32 v12, v12, v13
    v_cmp_eq_u32 vcc, -1, v12
    s_cbranch_vccnz L_kvs_44
    v_permlane16_swap_b32 v176, v180
    v_permlane16_swap_b32 v177, v181
    v_permlane16_swap_b32 v178, v182
    v_permlane16_swap_b32 v179, v183
    s_waitcnt vmcnt(12)
L_kvc_45:
    v_max3_u32 v12, v92, v93, v94
    v_max3_u32 v13, v184, v185, v186
    v_max3_u32 v12, v95, v187, v12
    v_max_u32 v12, v12, v13
    v_cmp_eq_u32 vcc, -1, v12
    s_cbranch_vccnz L_kvs_46
    v_permlane16_swap_b32 v184, v188
    v_permlane16_swap_b32 v185, v189
    v_permlane16_swap_b32 v186, v190
    v_permlane16_swap_b32 v187, v191
    v_exp_f32 v32, v32
    v_exp_f32 v33, v33
    v_smfmac_f32_32x32x32_bf16 v[16:31], v[140:143], v[56:63], v2
    v_exp_f32 v34, v34
    v_exp_f32 v35, v35
    v_exp_f32 v36, v36
    v_mfma_f32_32x32x16_bf16 v[48:63], v[76:79], v[8:11], 0
    v_exp_f32 v37, v37
    v_exp_f32 v38, v38
    v_exp_f32 v39, v39
    v_exp_f32 v40, v40
    v_exp_f32 v41, v41
    v_smfmac_f32_32x32x32_bf16 v[16:31], v[144:147], v[32:39], v2
    v_exp_f32 v42, v42
    v_exp_f32 v43, v43
    v_exp_f32 v44, v44
    v_exp_f32 v45, v45
    v_exp_f32 v46, v46
    v_exp_f32 v47, v47
    s_setprio 3
    s_add_u32 s4, s8, s9
    buffer_load_dwordx4 v[120:123], v5, s[44:47], s4 offen sc1
    buffer_load_dwordx4 v[240:243], v4, s[44:47], s4 offen sc1
    s_add_u32 s9, s9, 1024
    s_and_b32 s9, s9, 0x3fff
    s_add_u32 s4, s8, s9
    buffer_load_dwordx4 v[124:127], v5, s[44:47], s4 offen sc1
    buffer_load_dwordx4 v[248:251], v4, s[44:47], s4 offen sc1
    s_setprio 0
    v_mov_b32 v13, 1
    s_mov_b64 exec, 1
    ds_add_u32 v0, v13 offset:10568
    s_mov_b64 exec, -1
    s_waitcnt vmcnt(14)
L_kvc_47:
    v_max3_u32 v12, v96, v97, v98
    v_max3_u32 v13, v192, v193, v194
    v_max3_u32 v12, v99, v195, v12
    v_max_u32 v12, v12, v13
    v_cmp_eq_u32 vcc, -1, v12
    s_cbranch_vccnz L_kvs_48
    v_permlane16_swap_b32 v192, v196
    v_permlane16_swap_b32 v193, v197
    v_permlane16_swap_b32 v194, v198
    v_permlane16_swap_b32 v195, v199
    s_waitcnt vmcnt(12)
L_kvc_49:
    v_max3_u32 v12, v100, v101, v102
    v_max3_u32 v13, v200, v201, v202
    v_max3_u32 v12, v103, v203, v12
    v_max_u32 v12, v12, v13
    v_cmp_eq_u32 vcc, -1, v12
    s_cbranch_vccnz L_kvs_50
    v_permlane16_swap_b32 v200, v204
    v_permlane16_swap_b32 v201, v205
    v_permlane16_swap_b32 v202, v206
    v_permlane16_swap_b32 v203, v207
    v_exp_f32 v48, v48
    v_exp_f32 v49, v49
    v_smfmac_f32_32x32x32_bf16 v[16:31], v[148:151], v[40:47], v2
    v_exp_f32 v50, v50
    v_exp_f32 v51, v51
    v_exp_f32 v52, v52
    v_mfma_f32_32x32x16_bf16 v[32:47], v[80:83], v[8:11], 0
    v_exp_f32 v53, v53
    v_exp_f32 v54, v54
    v_exp_f32 v55, v55
    v_exp_f32 v56, v56
    v_exp_f32 v57, v57
    v_smfmac_f32_32x32x32_bf16 v[16:31], v[152:155], v[48:55], v2
    v_exp_f32 v58, v58
    v_exp_f32 v59, v59
    v_exp_f32 v60, v60
    v_exp_f32 v61, v61
    v_exp_f32 v62, v62
    v_exp_f32 v63, v63
    s_waitcnt vmcnt(10)
L_kvc_51:
    v_max3_u32 v12, v104, v105, v106
    v_max3_u32 v13, v208, v209, v210
    v_max3_u32 v12, v107, v211, v12
    v_max_u32 v12, v12, v13
    v_cmp_eq_u32 vcc, -1, v12
    s_cbranch_vccnz L_kvs_52
    v_permlane16_swap_b32 v208, v212
    v_permlane16_swap_b32 v209, v213
    v_permlane16_swap_b32 v210, v214
    v_permlane16_swap_b32 v211, v215
    s_waitcnt vmcnt(8)
L_kvc_53:
    v_max3_u32 v12, v108, v109, v110
    v_max3_u32 v13, v216, v217, v218
    v_max3_u32 v12, v111, v219, v12
    v_max_u32 v12, v12, v13
    v_cmp_eq_u32 vcc, -1, v12
    s_cbranch_vccnz L_kvs_54
    v_permlane16_swap_b32 v216, v220
    v_permlane16_swap_b32 v217, v221
    v_permlane16_swap_b32 v218, v222
    v_permlane16_swap_b32 v219, v223
    v_exp_f32 v32, v32
    v_exp_f32 v33, v33
    v_smfmac_f32_32x32x32_bf16 v[16:31], v[156:159], v[56:63], v2
    v_exp_f32 v34, v34
    v_exp_f32 v35, v35
    v_exp_f32 v36, v36
    v_mfma_f32_32x32x16_bf16 v[48:63], v[84:87], v[8:11], 0
    v_exp_f32 v37, v37
    v_exp_f32 v38, v38
    v_exp_f32 v39, v39
    v_exp_f32 v40, v40
    v_exp_f32 v41, v41
    v_smfmac_f32_32x32x32_bf16 v[16:31], v[160:163], v[32:39], v2
    v_exp_f32 v42, v42
    v_exp_f32 v43, v43
    v_exp_f32 v44, v44
    v_exp_f32 v45, v45
    v_exp_f32 v46, v46
    v_exp_f32 v47, v47
    s_waitcnt vmcnt(6)
L_kvc_55:
    v_max3_u32 v12, v112, v113, v114
    v_max3_u32 v13, v224, v225, v226
    v_max3_u32 v12, v115, v227, v12
    v_max_u32 v12, v12, v13
    v_cmp_eq_u32 vcc, -1, v12
    s_cbranch_vccnz L_kvs_56
    v_permlane16_swap_b32 v224, v228
    v_permlane16_swap_b32 v225, v229
    v_permlane16_swap_b32 v226, v230
    v_permlane16_swap_b32 v227, v231
    s_waitcnt vmcnt(4)
L_kvc_57:
    v_max3_u32 v12, v116, v117, v118
    v_max3_u32 v13, v232, v233, v234
    v_max3_u32 v12, v119, v235, v12
    v_max_u32 v12, v12, v13
    v_cmp_eq_u32 vcc, -1, v12
    s_cbranch_vccnz L_kvs_58
    v_permlane16_swap_b32 v232, v236
    v_permlane16_swap_b32 v233, v237
    v_permlane16_swap_b32 v234, v238
    v_permlane16_swap_b32 v235, v239
    v_exp_f32 v48, v48
    v_exp_f32 v49, v49
    v_smfmac_f32_32x32x32_bf16 v[16:31], v[164:167], v[40:47], v2
    v_exp_f32 v50, v50
    v_exp_f32 v51, v51
    v_exp_f32 v52, v52
    v_mfma_f32_32x32x16_bf16 v[32:47], v[88:91], v[8:11], 0
    v_exp_f32 v53, v53
    v_exp_f32 v54, v54
    v_exp_f32 v55, v55
    v_exp_f32 v56, v56
    v_exp_f32 v57, v57
    v_smfmac_f32_32x32x32_bf16 v[16:31], v[168:171], v[48:55], v2
    v_exp_f32 v58, v58
    v_exp_f32 v59, v59
    v_exp_f32 v60, v60
    v_exp_f32 v61, v61
    v_exp_f32 v62, v62
    v_exp_f32 v63, v63
    s_waitcnt vmcnt(2)
L_kvc_59:
    v_max3_u32 v12, v120, v121, v122
    v_max3_u32 v13, v240, v241, v242
    v_max3_u32 v12, v123, v243, v12
    v_max_u32 v12, v12, v13
    v_cmp_eq_u32 vcc, -1, v12
    s_cbranch_vccnz L_kvs_60
    v_permlane16_swap_b32 v240, v244
    v_permlane16_swap_b32 v241, v245
    v_permlane16_swap_b32 v242, v246
    v_permlane16_swap_b32 v243, v247
    s_waitcnt vmcnt(0)
L_kvc_61:
    v_max3_u32 v12, v124, v125, v126
    v_max3_u32 v13, v248, v249, v250
    v_max3_u32 v12, v127, v251, v12
    v_max_u32 v12, v12, v13
    v_cmp_eq_u32 vcc, -1, v12
    s_cbranch_vccnz L_kvs_62
    v_permlane16_swap_b32 v248, v252
    v_permlane16_swap_b32 v249, v253
    v_permlane16_swap_b32 v250, v254
    v_permlane16_swap_b32 v251, v255
    v_exp_f32 v32, v32
    v_exp_f32 v33, v33
    v_smfmac_f32_32x32x32_bf16 v[16:31], v[172:175], v[56:63], v2
    v_exp_f32 v34, v34
    v_exp_f32 v35, v35
    v_exp_f32 v36, v36
    v_mfma_f32_32x32x16_bf16 v[48:63], v[92:95], v[8:11], 0
    v_exp_f32 v37, v37
    v_exp_f32 v38, v38
    v_exp_f32 v39, v39
    v_exp_f32 v40, v40
    v_exp_f32 v41, v41
    v_smfmac_f32_32x32x32_bf16 v[16:31], v[176:179], v[32:39], v2
    v_exp_f32 v42, v42
    v_exp_f32 v43, v43
    v_exp_f32 v44, v44
    v_exp_f32 v45, v45
    v_exp_f32 v46, v46
    v_exp_f32 v47, v47
    s_branch L_cloopt1_12
L_upfront_29:
    s_add_u32 s4, s8, s9
    buffer_load_dwordx4 v[96:99], v5, s[44:47], s4 offen sc1
    buffer_load_dwordx4 v[192:195], v4, s[44:47], s4 offen sc1
    s_add_u32 s9, s9, 1024
    s_and_b32 s9, s9, 0x3fff
    s_add_u32 s4, s8, s9
    buffer_load_dwordx4 v[100:103], v5, s[44:47], s4 offen sc1
    buffer_load_dwordx4 v[200:203], v4, s[44:47], s4 offen sc1
    s_add_u32 s9, s9, 1024
    s_and_b32 s9, s9, 0x3fff
    s_add_u32 s4, s8, s9
    buffer_load_dwordx4 v[104:107], v5, s[44:47], s4 offen sc1
    buffer_load_dwordx4 v[208:211], v4, s[44:47], s4 offen sc1
    s_add_u32 s9, s9, 1024
    s_and_b32 s9, s9, 0x3fff
    s_add_u32 s4, s8, s9
    buffer_load_dwordx4 v[108:111], v5, s[44:47], s4 offen sc1
    buffer_load_dwordx4 v[216:219], v4, s[44:47], s4 offen sc1
    s_add_u32 s9, s9, 1024
    s_and_b32 s9, s9, 0x3fff
    s_setprio 0
    s_add_u32 s4, s8, s9
    buffer_load_dwordx4 v[112:115], v5, s[44:47], s4 offen sc1
    buffer_load_dwordx4 v[224:227], v4, s[44:47], s4 offen sc1
    s_add_u32 s9, s9, 1024
    s_and_b32 s9, s9, 0x3fff
    s_setprio 0
    s_waitcnt vmcnt(24)
L_kvc_63:
    v_max3_u32 v12, v64, v65, v66
    v_max3_u32 v13, v128, v129, v130
    v_max3_u32 v12, v67, v131, v12
    v_max_u32 v12, v12, v13
    v_cmp_eq_u32 vcc, -1, v12
    s_cbranch_vccnz L_kvs_64
    v_permlane16_swap_b32 v128, v132
    v_permlane16_swap_b32 v129, v133
    v_permlane16_swap_b32 v130, v134
    v_permlane16_swap_b32 v131, v135
    s_add_u32 s4, s8, s9
    buffer_load_dwordx4 v[116:119], v5, s[44:47], s4 offen sc1
    buffer_load_dwordx4 v[232:235], v4, s[44:47], s4 offen sc1
    s_add_u32 s9, s9, 1024
    s_and_b32 s9, s9, 0x3fff
    s_setprio 0
    s_waitcnt vmcnt(24)
L_kvc_65:
    v_max3_u32 v12, v68, v69, v70
    v_max3_u32 v13, v136, v137, v138
    v_max3_u32 v12, v71, v139, v12
    v_max_u32 v12, v12, v13
    v_cmp_eq_u32 vcc, -1, v12
    s_cbranch_vccnz L_kvs_66
    v_permlane16_swap_b32 v136, v140
    v_permlane16_swap_b32 v137, v141
    v_permlane16_swap_b32 v138, v142
    v_permlane16_swap_b32 v139, v143
    s_add_u32 s4, s8, s9
    buffer_load_dwordx4 v[120:123], v5, s[44:47], s4 offen sc1
    buffer_load_dwordx4 v[240:243], v4, s[44:47], s4 offen sc1
    s_add_u32 s9, s9, 1024
    s_and_b32 s9, s9, 0x3fff
    s_setprio 0
    s_waitcnt vmcnt(24)
L_kvc_67:
    v_max3_u32 v12, v72, v73, v74
    v_max3_u32 v13, v144, v145, v146
    v_max3_u32 v12, v75, v147, v12
    v_max_u32 v12, v12, v13
    v_cmp_eq_u32 vcc, -1, v12
    s_cbranch_vccnz L_kvs_68
    v_permlane16_swap_b32 v144, v148
    v_permlane16_swap_b32 v145, v149
    v_permlane16_swap_b32 v146, v150
    v_permlane16_swap_b32 v147, v151
    s_add_u32 s4, s8, s9
    buffer_load_dwordx4 v[124:127], v5, s[44:47], s4 offen sc1
    buffer_load_dwordx4 v[248:251], v4, s[44:47], s4 offen sc1
    s_setprio 0
    v_mov_b32 v13, 1
    s_mov_b64 exec, 1
    ds_add_u32 v0, v13 offset:10568
    s_mov_b64 exec, -1
    s_waitcnt vmcnt(24)
L_kvc_69:
    v_max3_u32 v12, v76, v77, v78
    v_max3_u32 v13, v152, v153, v154
    v_max3_u32 v12, v79, v155, v12
    v_max_u32 v12, v12, v13
    v_cmp_eq_u32 vcc, -1, v12
    s_cbranch_vccnz L_kvs_70
    v_permlane16_swap_b32 v152, v156
    v_permlane16_swap_b32 v153, v157
    v_permlane16_swap_b32 v154, v158
    v_permlane16_swap_b32 v155, v159
    s_waitcnt vmcnt(22)
L_kvc_71:
    v_max3_u32 v12, v80, v81, v82
    v_max3_u32 v13, v160, v161, v162
    v_max3_u32 v12, v83, v163, v12
    v_max_u32 v12, v12, v13
    v_cmp_eq_u32 vcc, -1, v12
    s_cbranch_vccnz L_kvs_72
    v_permlane16_swap_b32 v160, v164
    v_permlane16_swap_b32 v161, v165
    v_permlane16_swap_b32 v162, v166
    v_permlane16_swap_b32 v163, v167
    s_waitcnt vmcnt(20)
L_kvc_73:
    v_max3_u32 v12, v84, v85, v86
    v_max3_u32 v13, v168, v169, v170
    v_max3_u32 v12, v87, v171, v12
    v_max_u32 v12, v12, v13
    v_cmp_eq_u32 vcc, -1, v12
    s_cbranch_vccnz L_kvs_74
    v_permlane16_swap_b32 v168, v172
    v_permlane16_swap_b32 v169, v173
    v_permlane16_swap_b32 v170, v174
    v_permlane16_swap_b32 v171, v175
    s_waitcnt vmcnt(18)
L_kvc_75:
    v_max3_u32 v12, v88, v89, v90
    v_max3_u32 v13, v176, v177, v178
    v_max3_u32 v12, v91, v179, v12
    v_max_u32 v12, v12, v13
    v_cmp_eq_u32 vcc, -1, v12
    s_cbranch_vccnz L_kvs_76
    v_permlane16_swap_b32 v176, v180
    v_permlane16_swap_b32 v177, v181
    v_permlane16_swap_b32 v178, v182
    v_permlane16_swap_b32 v179, v183
    s_waitcnt vmcnt(16)
L_kvc_77:
    v_max3_u32 v12, v92, v93, v94
    v_max3_u32 v13, v184, v185, v186
    v_max3_u32 v12, v95, v187, v12
    v_max_u32 v12, v12, v13
    v_cmp_eq_u32 vcc, -1, v12
    s_cbranch_vccnz L_kvs_78
    v_permlane16_swap_b32 v184, v188
    v_permlane16_swap_b32 v185, v189
    v_permlane16_swap_b32 v186, v190
    v_permlane16_swap_b32 v187, v191
    s_waitcnt vmcnt(14)
L_kvc_79:
    v_max3_u32 v12, v96, v97, v98
    v_max3_u32 v13, v192, v193, v194
    v_max3_u32 v12, v99, v195, v12
    v_max_u32 v12, v12, v13
    v_cmp_eq_u32 vcc, -1, v12
    s_cbranch_vccnz L_kvs_80
    v_permlane16_swap_b32 v192, v196
    v_permlane16_swap_b32 v193, v197
    v_permlane16_swap_b32 v194, v198
    v_permlane16_swap_b32 v195, v199
    s_waitcnt vmcnt(12)
L_kvc_81:
    v_max3_u32 v12, v100, v101, v102
    v_max3_u32 v13, v200, v201, v202
    v_max3_u32 v12, v103, v203, v12
    v_max_u32 v12, v12, v13
    v_cmp_eq_u32 vcc, -1, v12
    s_cbranch_vccnz L_kvs_82
    v_permlane16_swap_b32 v200, v204
    v_permlane16_swap_b32 v201, v205
    v_permlane16_swap_b32 v202, v206
    v_permlane16_swap_b32 v203, v207
    s_waitcnt vmcnt(10)
L_kvc_83:
    v_max3_u32 v12, v104, v105, v106
    v_max3_u32 v13, v208, v209, v210
    v_max3_u32 v12, v107, v211, v12
    v_max_u32 v12, v12, v13
    v_cmp_eq_u32 vcc, -1, v12
    s_cbranch_vccnz L_kvs_84
    v_permlane16_swap_b32 v208, v212
    v_permlane16_swap_b32 v209, v213
    v_permlane16_swap_b32 v210, v214
    v_permlane16_swap_b32 v211, v215
    s_waitcnt vmcnt(8)
L_kvc_85:
    v_max3_u32 v12, v108, v109, v110
    v_max3_u32 v13, v216, v217, v218
    v_max3_u32 v12, v111, v219, v12
    v_max_u32 v12, v12, v13
    v_cmp_eq_u32 vcc, -1, v12
    s_cbranch_vccnz L_kvs_86
    v_permlane16_swap_b32 v216, v220
    v_permlane16_swap_b32 v217, v221
    v_permlane16_swap_b32 v218, v222
    v_permlane16_swap_b32 v219, v223
    s_waitcnt vmcnt(6)
L_kvc_87:
    v_max3_u32 v12, v112, v113, v114
    v_max3_u32 v13, v224, v225, v226
    v_max3_u32 v12, v115, v227, v12
    v_max_u32 v12, v12, v13
    v_cmp_eq_u32 vcc, -1, v12
    s_cbranch_vccnz L_kvs_88
    v_permlane16_swap_b32 v224, v228
    v_permlane16_swap_b32 v225, v229
    v_permlane16_swap_b32 v226, v230
    v_permlane16_swap_b32 v227, v231
    s_waitcnt vmcnt(4)
L_kvc_89:
    v_max3_u32 v12, v116, v117, v118
    v_max3_u32 v13, v232, v233, v234
    v_max3_u32 v12, v119, v235, v12
    v_max_u32 v12, v12, v13
    v_cmp_eq_u32 vcc, -1, v12
    s_cbranch_vccnz L_kvs_90
    v_permlane16_swap_b32 v232, v236
    v_permlane16_swap_b32 v233, v237
    v_permlane16_swap_b32 v234, v238
    v_permlane16_swap_b32 v235, v239
    s_waitcnt vmcnt(2)
L_kvc_91:
    v_max3_u32 v12, v120, v121, v122
    v_max3_u32 v13, v240, v241, v242
    v_max3_u32 v12, v123, v243, v12
    v_max_u32 v12, v12, v13
    v_cmp_eq_u32 vcc, -1, v12
    s_cbranch_vccnz L_kvs_92
    v_permlane16_swap_b32 v240, v244
    v_permlane16_swap_b32 v241, v245
    v_permlane16_swap_b32 v242, v246
    v_permlane16_swap_b32 v243, v247
    s_waitcnt vmcnt(0)
L_kvc_93:
    v_max3_u32 v12, v124, v125, v126
    v_max3_u32 v13, v248, v249, v250
    v_max3_u32 v12, v127, v251, v12
    v_max_u32 v12, v12, v13
    v_cmp_eq_u32 vcc, -1, v12
    s_cbranch_vccnz L_kvs_94
    v_permlane16_swap_b32 v248, v252
    v_permlane16_swap_b32 v249, v253
    v_permlane16_swap_b32 v250, v254
    v_permlane16_swap_b32 v251, v255
    v_mov_b32 v0, 0
    v_mov_b32 v1, 0
L_q0wait_95:
    s_sub_u32 s14, s14, 1
    s_cbranch_scc1 L_end_1
    ds_read_b32 v6, v3 offset:1024
    ds_read_b128 v[8:11], v5 offset:0
    s_waitcnt lgkmcnt(0)
    v_readfirstlane_b32 s4, v6
    s_cmp_eq_u32 s4, 4
    s_cbranch_scc0 L_q0wait_95
    v_mfma_f32_32x32x16_bf16 v[32:47], v[64:67], v[8:11], 0
    s_mov_b32 s12, 3
    s_nop 10
    v_exp_f32 v32, v32
    v_exp_f32 v33, v33
    v_exp_f32 v34, v34
    v_exp_f32 v35, v35
    v_exp_f32 v36, v36
    v_mfma_f32_32x32x16_bf16 v[48:63], v[68:71], v[8:11], 0
    v_exp_f32 v37, v37
    v_exp_f32 v38, v38
    v_exp_f32 v39, v39
    v_exp_f32 v40, v40
    v_exp_f32 v41, v41
    v_exp_f32 v42, v42
    v_exp_f32 v43, v43
    v_exp_f32 v44, v44
    v_mfma_f32_32x32x8_bf16 v[16:31], v[0:1], v[0:1], 0
    v_exp_f32 v45, v45
    v_exp_f32 v46, v46
    v_exp_f32 v47, v47
    s_branch L_cloopt1b_30
.p2align 6
L_cloop_10:
    v_exp_f32 v32, v32
    v_exp_f32 v33, v33
    v_smfmac_f32_32x32x32_bf16 v[16:31], v[252:255], v[56:63], v2
    v_exp_f32 v34, v34
    v_exp_f32 v35, v35
    v_exp_f32 v36, v36
    v_mfma_f32_32x32x16_bf16 v[48:63], v[68:71], v[8:11], 0
    v_exp_f32 v37, v37
    v_exp_f32 v38, v38
    v_exp_f32 v39, v39
    v_exp_f32 v40, v40
    v_exp_f32 v41, v41
    v_exp_f32 v42, v42
    v_exp_f32 v43, v43
    v_exp_f32 v44, v44
    ds_write_addtid_b32 v16 offset:9216
    ds_write_addtid_b32 v17 offset:9472
    ds_write_addtid_b32 v18 offset:9728
    ds_write_addtid_b32 v19 offset:9984
    ds_write_addtid_b32 v20 offset:10240
    ds_write_addtid_b32 v21 offset:10496
    ds_write_addtid_b32 v22 offset:10752
    ds_write_addtid_b32 v23 offset:11008
    ds_write_addtid_b32 v24 offset:11264
    v_mfma_f32_32x32x8_bf16 v[16:31], v[0:1], v[0:1], 0
    v_exp_f32 v45, v45
    v_exp_f32 v46, v46
    v_exp_f32 v47, v47
L_cloopt1b_30:
    v_smfmac_f32_32x32x32_bf16 v[16:31], v[128:131], v[32:39], v2
    v_exp_f32 v48, v48
    v_exp_f32 v49, v49
    v_exp_f32 v50, v50
    v_smfmac_f32_32x32x32_bf16 v[16:31], v[132:135], v[40:47], v2
    v_exp_f32 v51, v51
    v_exp_f32 v52, v52
    v_exp_f32 v53, v53
    v_mfma_f32_32x32x16_bf16 v[32:47], v[72:75], v[8:11], 0
    v_exp_f32 v54, v54
    v_exp_f32 v55, v55
    v_exp_f32 v56, v56
    v_exp_f32 v57, v57
    v_smfmac_f32_32x32x32_bf16 v[16:31], v[136:139], v[48:55], v2
    v_exp_f32 v58, v58
    v_exp_f32 v59, v59
    v_exp_f32 v60, v60
    v_exp_f32 v61, v61
    v_exp_f32 v62, v62
    v_exp_f32 v63, v63
    s_nop 0
    v_exp_f32 v32, v32
    v_exp_f32 v33, v33
    v_smfmac_f32_32x32x32_bf16 v[16:31], v[140:143], v[56:63], v2
    v_exp_f32 v34, v34
    v_exp_f32 v35, v35
    v_exp_f32 v36, v36
    v_mfma_f32_32x32x16_bf16 v[48:63], v[76:79], v[8:11], 0
    v_exp_f32 v37, v37
    v_exp_f32 v38, v38
    v_exp_f32 v39, v39
    v_exp_f32 v40, v40
    v_exp_f32 v41, v41
    v_smfmac_f32_32x32x32_bf16 v[16:31], v[144:147], v[32:39], v2
    v_exp_f32 v42, v42
    v_exp_f32 v43, v43
    v_exp_f32 v44, v44
    v_exp_f32 v45, v45
    v_exp_f32 v46, v46
    v_exp_f32 v47, v47
    v_exp_f32 v48, v48
    v_exp_f32 v49, v49
    v_smfmac_f32_32x32x32_bf16 v[16:31], v[148:151], v[40:47], v2
    v_exp_f32 v50, v50
    v_exp_f32 v51, v51
    v_exp_f32 v52, v52
    v_mfma_f32_32x32x16_bf16 v[32:47], v[80:83], v[8:11], 0
    v_exp_f32 v53, v53
    v_exp_f32 v54, v54
    v_exp_f32 v55, v55
    v_exp_f32 v56, v56
    v_exp_f32 v57, v57
    v_smfmac_f32_32x32x32_bf16 v[16:31], v[152:155], v[48:55], v2
    v_exp_f32 v58, v58
    v_exp_f32 v59, v59
    v_exp_f32 v60, v60
    v_exp_f32 v61, v61
    v_exp_f32 v62, v62
    v_exp_f32 v63, v63
    v_exp_f32 v32, v32
    v_exp_f32 v33, v33
    v_smfmac_f32_32x32x32_bf16 v[16:31], v[156:159], v[56:63], v2
    v_exp_f32 v34, v34
    v_exp_f32 v35, v35
    v_exp_f32 v36, v36
    v_mfma_f32_32x32x16_bf16 v[48:63], v[84:87], v[8:11], 0
    v_exp_f32 v37, v37
    v_exp_f32 v38, v38
    v_exp_f32 v39, v39
    v_exp_f32 v40, v40
    v_exp_f32 v41, v41
    v_smfmac_f32_32x32x32_bf16 v[16:31], v[160:163], v[32:39], v2
    v_exp_f32 v42, v42
    v_exp_f32 v43, v43
    v_exp_f32 v44, v44
    v_exp_f32 v45, v45
    v_exp_f32 v46, v46
    v_exp_f32 v47, v47
    v_exp_f32 v48, v48
    v_exp_f32 v49, v49
    v_smfmac_f32_32x32x32_bf16 v[16:31], v[164:167], v[40:47], v2
    v_exp_f32 v50, v50
    v_exp_f32 v51, v51
    v_exp_f32 v52, v52
    v_mfma_f32_32x32x16_bf16 v[32:47], v[88:91], v[8:11], 0
    v_exp_f32 v53, v53
    v_exp_f32 v54, v54
    v_exp_f32 v55, v55
    v_exp_f32 v56, v56
    v_exp_f32 v57, v57
    v_smfmac_f32_32x32x32_bf16 v[16:31], v[168:171], v[48:55], v2
    v_exp_f32 v58, v58
    v_exp_f32 v59, v59
    v_exp_f32 v60, v60
    v_exp_f32 v61, v61
    v_exp_f32 v62, v62
    v_exp_f32 v63, v63
    v_exp_f32 v32, v32
    v_exp_f32 v33, v33
    v_smfmac_f32_32x32x32_bf16 v[16:31], v[172:175], v[56:63], v2
    v_exp_f32 v34, v34
    v_exp_f32 v35, v35
    v_exp_f32 v36, v36
    v_mfma_f32_32x32x16_bf16 v[48:63], v[92:95], v[8:11], 0
    v_exp_f32 v37, v37
    v_exp_f32 v38, v38
    v_exp_f32 v39, v39
    v_exp_f32 v40, v40
    v_exp_f32 v41, v41
    v_smfmac_f32_32x32x32_bf16 v[16:31], v[176:179], v[32:39], v2
    v_exp_f32 v42, v42
    v_exp_f32 v43, v43
    v_exp_f32 v44, v44
    v_exp_f32 v45, v45
    v_exp_f32 v46, v46
    v_exp_f32 v47, v47
L_cloopt1_12:
    v_exp_f32 v48, v48
    v_exp_f32 v49, v49
    v_smfmac_f32_32x32x32_bf16 v[16:31], v[180:183], v[40:47], v2
    v_exp_f32 v50, v50
    v_exp_f32 v51, v51
    v_exp_f32 v52, v52
    v_mfma_f32_32x32x16_bf16 v[32:47], v[96:99], v[8:11], 0
    v_exp_f32 v53, v53
    v_exp_f32 v54, v54
    v_exp_f32 v55, v55
    v_exp_f32 v56, v56
    v_exp_f32 v57, v57
    v_smfmac_f32_32x32x32_bf16 v[16:31], v[184:187], v[48:55], v2
    v_exp_f32 v58, v58
    v_exp_f32 v59, v59
    v_exp_f32 v60, v60
    v_exp_f32 v61, v61
    v_exp_f32 v62, v62
    v_exp_f32 v63, v63
    v_exp_f32 v32, v32
    v_exp_f32 v33, v33
    v_smfmac_f32_32x32x32_bf16 v[16:31], v[188:191], v[56:63], v2
    v_exp_f32 v34, v34
    v_exp_f32 v35, v35
    v_exp_f32 v36, v36
    v_mfma_f32_32x32x16_bf16 v[48:63], v[100:103], v[8:11], 0
    v_exp_f32 v37, v37
    v_exp_f32 v38, v38
    v_exp_f32 v39, v39
    v_exp_f32 v40, v40
    v_exp_f32 v41, v41
    v_smfmac_f32_32x32x32_bf16 v[16:31], v[192:195], v[32:39], v2
    v_exp_f32 v42, v42
    v_exp_f32 v43, v43
    v_exp_f32 v44, v44
    v_exp_f32 v45, v45
    v_exp_f32 v46, v46
    v_exp_f32 v47, v47
    v_exp_f32 v48, v48
    v_exp_f32 v49, v49
    v_smfmac_f32_32x32x32_bf16 v[16:31], v[196:199], v[40:47], v2
    v_exp_f32 v50, v50
    v_exp_f32 v51, v51
    v_exp_f32 v52, v52
    v_mfma_f32_32x32x16_bf16 v[32:47], v[104:107], v[8:11], 0
    v_exp_f32 v53, v53
    v_exp_f32 v54, v54
    v_exp_f32 v55, v55
    v_exp_f32 v56, v56
    v_exp_f32 v57, v57
    v_smfmac_f32_32x32x32_bf16 v[16:31], v[200:203], v[48:55], v2
    v_exp_f32 v58, v58
    v_exp_f32 v59, v59
    v_exp_f32 v60, v60
    v_exp_f32 v61, v61
    v_exp_f32 v62, v62
    v_exp_f32 v63, v63
    v_exp_f32 v32, v32
    v_exp_f32 v33, v33
    v_smfmac_f32_32x32x32_bf16 v[16:31], v[204:207], v[56:63], v2
    v_exp_f32 v34, v34
    v_exp_f32 v35, v35
    v_exp_f32 v36, v36
    v_mfma_f32_32x32x16_bf16 v[48:63], v[108:111], v[8:11], 0
    v_exp_f32 v37, v37
    v_exp_f32 v38, v38
    v_exp_f32 v39, v39
    v_exp_f32 v40, v40
    v_exp_f32 v41, v41
    v_smfmac_f32_32x32x32_bf16 v[16:31], v[208:211], v[32:39], v2
    v_exp_f32 v42, v42
    v_exp_f32 v43, v43
    v_exp_f32 v44, v44
    v_exp_f32 v45, v45
    v_exp_f32 v46, v46
    v_exp_f32 v47, v47
    v_exp_f32 v48, v48
    v_exp_f32 v49, v49
    v_smfmac_f32_32x32x32_bf16 v[16:31], v[212:215], v[40:47], v2
    v_exp_f32 v50, v50
    v_exp_f32 v51, v51
    v_exp_f32 v52, v52
    v_mfma_f32_32x32x16_bf16 v[32:47], v[112:115], v[8:11], 0
    v_exp_f32 v53, v53
    v_exp_f32 v54, v54
    v_exp_f32 v55, v55
    v_exp_f32 v56, v56
    v_exp_f32 v57, v57
    v_smfmac_f32_32x32x32_bf16 v[16:31], v[216:219], v[48:55], v2
    v_exp_f32 v58, v58
    v_exp_f32 v59, v59
    v_exp_f32 v60, v60
    v_exp_f32 v61, v61
    v_exp_f32 v62, v62
    v_exp_f32 v63, v63
    ds_read_b32 v6, v3 offset:2064
    ds_read_b128 v[12:15], v5 offset:1040
    v_exp_f32 v32, v32
    v_exp_f32 v33, v33
    v_smfmac_f32_32x32x32_bf16 v[16:31], v[220:223], v[56:63], v2
    v_exp_f32 v34, v34
    v_exp_f32 v35, v35
    v_exp_f32 v36, v36
    v_mfma_f32_32x32x16_bf16 v[48:63], v[116:119], v[8:11], 0
    v_exp_f32 v37, v37
    v_exp_f32 v38, v38
    v_exp_f32 v39, v39
    v_exp_f32 v40, v40
    v_exp_f32 v41, v41
    v_smfmac_f32_32x32x32_bf16 v[16:31], v[224:227], v[32:39], v2
    v_exp_f32 v42, v42
    v_exp_f32 v43, v43
    v_exp_f32 v44, v44
    v_exp_f32 v45, v45
    v_exp_f32 v46, v46
    v_exp_f32 v47, v47
    v_exp_f32 v48, v48
    v_exp_f32 v49, v49
    v_smfmac_f32_32x32x32_bf16 v[16:31], v[228:231], v[40:47], v2
    v_exp_f32 v50, v50
    v_exp_f32 v51, v51
    v_exp_f32 v52, v52
    v_mfma_f32_32x32x16_bf16 v[32:47], v[120:123], v[8:11], 0
    v_exp_f32 v53, v53
    v_exp_f32 v54, v54
    v_exp_f32 v55, v55
    v_exp_f32 v56, v56
    v_exp_f32 v57, v57
    v_smfmac_f32_32x32x32_bf16 v[16:31], v[232:235], v[48:55], v2
    v_exp_f32 v58, v58
    v_exp_f32 v59, v59
    s_waitcnt lgkmcnt(0)
    v_cmp_ne_u32 vcc, s13, v6
    v_exp_f32 v60, v60
    v_exp_f32 v61, v61
    v_exp_f32 v62, v62
    v_exp_f32 v63, v63
    s_cbranch_vccnz L_qretry_96
L_qok_97:
    v_exp_f32 v32, v32
    v_exp_f32 v33, v33
    v_smfmac_f32_32x32x32_bf16 v[16:31], v[236:239], v[56:63], v2
    v_exp_f32 v34, v34
    v_exp_f32 v35, v35
    v_exp_f32 v36, v36
    v_mfma_f32_32x32x16_bf16 v[48:63], v[124:127], v[8:11], 0
    v_exp_f32 v37, v37
    v_exp_f32 v38, v38
    v_exp_f32 v39, v39
    v_exp_f32 v40, v40
    v_exp_f32 v41, v41
    v_smfmac_f32_32x32x32_bf16 v[16:31], v[240:243], v[32:39], v2
    v_exp_f32 v42, v42
    v_exp_f32 v43, v43
    v_exp_f32 v44, v44
    v_exp_f32 v45, v45
    v_exp_f32 v46, v46
    v_exp_f32 v47, v47
    v_exp_f32 v48, v48
    v_exp_f32 v49, v49
    v_smfmac_f32_32x32x32_bf16 v[16:31], v[244:247], v[40:47], v2
    v_exp_f32 v50, v50
    v_exp_f32 v51, v51
    v_exp_f32 v52, v52
    v_mfma_f32_32x32x16_bf16 v[32:47], v[64:67], v[12:15], 0
    v_exp_f32 v53, v53
    v_exp_f32 v54, v54
    v_exp_f32 v55, v55
    v_exp_f32 v56, v56
    v_exp_f32 v57, v57
    v_smfmac_f32_32x32x32_bf16 v[16:31], v[248:251], v[48:55], v2
    v_exp_f32 v58, v58
    v_exp_f32 v59, v59
    v_exp_f32 v60, v60
    v_exp_f32 v61, v61
    v_exp_f32 v62, v62
    v_exp_f32 v63, v63
L_cloopb_11:
    v_exp_f32 v32, v32
    v_exp_f32 v33, v33
    v_smfmac_f32_32x32x32_bf16 v[16:31], v[252:255], v[56:63], v2
    v_exp_f32 v34, v34
    v_exp_f32 v35, v35
    v_exp_f32 v36, v36
    v_mfma_f32_32x32x16_bf16 v[48:63], v[68:71], v[12:15], 0
    v_exp_f32 v37, v37
    v_exp_f32 v38, v38
    v_exp_f32 v39, v39
    v_exp_f32 v40, v40
    v_exp_f32 v41, v41
    v_exp_f32 v42, v42
    v_exp_f32 v43, v43
    v_exp_f32 v44, v44
    ds_write_addtid_b32 v16 offset:0
    ds_write_addtid_b32 v17 offset:256
    ds_write_addtid_b32 v18 offset:512
    ds_write_addtid_b32 v19 offset:768
    ds_write_addtid_b32 v20 offset:1024
    ds_write_addtid_b32 v21 offset:1280
    ds_write_addtid_b32 v22 offset:1536
    ds_write_addtid_b32 v23 offset:1792
    ds_write_addtid_b32 v24 offset:2048
    v_mfma_f32_32x32x8_bf16 v[16:31], v[0:1], v[0:1], 0
    v_exp_f32 v45, v45
    v_exp_f32 v46, v46
    v_exp_f32 v47, v47
    v_smfmac_f32_32x32x32_bf16 v[16:31], v[128:131], v[32:39], v2
    v_exp_f32 v48, v48
    v_exp_f32 v49, v49
    v_exp_f32 v50, v50
    v_smfmac_f32_32x32x32_bf16 v[16:31], v[132:135], v[40:47], v2
    v_exp_f32 v51, v51
    v_exp_f32 v52, v52
    v_exp_f32 v53, v53
    v_mfma_f32_32x32x16_bf16 v[32:47], v[72:75], v[12:15], 0
    v_exp_f32 v54, v54
    v_exp_f32 v55, v55
    v_exp_f32 v56, v56
    v_exp_f32 v57, v57
    v_smfmac_f32_32x32x32_bf16 v[16:31], v[136:139], v[48:55], v2
    v_exp_f32 v58, v58
    v_exp_f32 v59, v59
    v_exp_f32 v60, v60
    v_exp_f32 v61, v61
    v_exp_f32 v62, v62
    v_exp_f32 v63, v63
    s_nop 0
    v_exp_f32 v32, v32
    v_exp_f32 v33, v33
    v_smfmac_f32_32x32x32_bf16 v[16:31], v[140:143], v[56:63], v2
    v_exp_f32 v34, v34
    v_exp_f32 v35, v35
    v_exp_f32 v36, v36
    v_mfma_f32_32x32x16_bf16 v[48:63], v[76:79], v[12:15], 0
    v_exp_f32 v37, v37
    v_exp_f32 v38, v38
    v_exp_f32 v39, v39
    v_exp_f32 v40, v40
    v_exp_f32 v41, v41
    v_smfmac_f32_32x32x32_bf16 v[16:31], v[144:147], v[32:39], v2
    v_exp_f32 v42, v42
    v_exp_f32 v43, v43
    v_exp_f32 v44, v44
    v_exp_f32 v45, v45
    v_exp_f32 v46, v46
    v_exp_f32 v47, v47
    v_exp_f32 v48, v48
    v_exp_f32 v49, v49
    v_smfmac_f32_32x32x32_bf16 v[16:31], v[148:151], v[40:47], v2
    v_exp_f32 v50, v50
    v_exp_f32 v51, v51
    v_exp_f32 v52, v52
    v_mfma_f32_32x32x16_bf16 v[32:47], v[80:83], v[12:15], 0
    v_exp_f32 v53, v53
    v_exp_f32 v54, v54
    v_exp_f32 v55, v55
    v_exp_f32 v56, v56
    v_exp_f32 v57, v57
    v_smfmac_f32_32x32x32_bf16 v[16:31], v[152:155], v[48:55], v2
    v_exp_f32 v58, v58
    v_exp_f32 v59, v59
    v_exp_f32 v60, v60
    v_exp_f32 v61, v61
    v_exp_f32 v62, v62
    v_exp_f32 v63, v63
    v_exp_f32 v32, v32
    v_exp_f32 v33, v33
    v_smfmac_f32_32x32x32_bf16 v[16:31], v[156:159], v[56:63], v2
    v_exp_f32 v34, v34
    v_exp_f32 v35, v35
    v_exp_f32 v36, v36
    v_mfma_f32_32x32x16_bf16 v[48:63], v[84:87], v[12:15], 0
    v_exp_f32 v37, v37
    v_exp_f32 v38, v38
    v_exp_f32 v39, v39
    v_exp_f32 v40, v40
    v_exp_f32 v41, v41
    v_smfmac_f32_32x32x32_bf16 v[16:31], v[160:163], v[32:39], v2
    v_exp_f32 v42, v42
    v_exp_f32 v43, v43
    v_exp_f32 v44, v44
    v_exp_f32 v45, v45
    v_exp_f32 v46, v46
    v_exp_f32 v47, v47
    v_exp_f32 v48, v48
    v_exp_f32 v49, v49
    v_smfmac_f32_32x32x32_bf16 v[16:31], v[164:167], v[40:47], v2
    v_exp_f32 v50, v50
    v_exp_f32 v51, v51
    v_exp_f32 v52, v52
    v_mfma_f32_32x32x16_bf16 v[32:47], v[88:91], v[12:15], 0
    v_exp_f32 v53, v53
    v_exp_f32 v54, v54
    v_exp_f32 v55, v55
    v_exp_f32 v56, v56
    v_exp_f32 v57, v57
    v_smfmac_f32_32x32x32_bf16 v[16:31], v[168:171], v[48:55], v2
    v_exp_f32 v58, v58
    v_exp_f32 v59, v59
    v_exp_f32 v60, v60
    v_exp_f32 v61, v61
    v_exp_f32 v62, v62
    v_exp_f32 v63, v63
    v_exp_f32 v32, v32
    v_exp_f32 v33, v33
    v_smfmac_f32_32x32x32_bf16 v[16:31], v[172:175], v[56:63], v2
    v_exp_f32 v34, v34
    v_exp_f32 v35, v35
    v_exp_f32 v36, v36
    v_mfma_f32_32x32x16_bf16 v[48:63], v[92:95], v[12:15], 0
    v_exp_f32 v37, v37
    v_exp_f32 v38, v38
    v_exp_f32 v39, v39
    v_exp_f32 v40, v40
    v_exp_f32 v41, v41
    v_smfmac_f32_32x32x32_bf16 v[16:31], v[176:179], v[32:39], v2
    v_exp_f32 v42, v42
    v_exp_f32 v43, v43
    v_exp_f32 v44, v44
    v_exp_f32 v45, v45
    v_exp_f32 v46, v46
    v_exp_f32 v47, v47
    v_exp_f32 v48, v48
    v_exp_f32 v49, v49
    v_smfmac_f32_32x32x32_bf16 v[16:31], v[180:183], v[40:47], v2
    v_exp_f32 v50, v50
    v_exp_f32 v51, v51
    v_exp_f32 v52, v52
    v_mfma_f32_32x32x16_bf16 v[32:47], v[96:99], v[12:15], 0
    v_exp_f32 v53, v53
    v_exp_f32 v54, v54
    v_exp_f32 v55, v55
    v_exp_f32 v56, v56
    v_exp_f32 v57, v57
    v_smfmac_f32_32x32x32_bf16 v[16:31], v[184:187], v[48:55], v2
    v_exp_f32 v58, v58
    v_exp_f32 v59, v59
    v_exp_f32 v60, v60
    v_exp_f32 v61, v61
    v_exp_f32 v62, v62
    v_exp_f32 v63, v63
    v_exp_f32 v32, v32
    v_exp_f32 v33, v33
    v_smfmac_f32_32x32x32_bf16 v[16:31], v[188:191], v[56:63], v2
    v_exp_f32 v34, v34
    v_exp_f32 v35, v35
    v_exp_f32 v36, v36
    v_mfma_f32_32x32x16_bf16 v[48:63], v[100:103], v[12:15], 0
    v_exp_f32 v37, v37
    v_exp_f32 v38, v38
    v_exp_f32 v39, v39
    v_exp_f32 v40, v40
    v_exp_f32 v41, v41
    v_smfmac_f32_32x32x32_bf16 v[16:31], v[192:195], v[32:39], v2
    v_exp_f32 v42, v42
    v_exp_f32 v43, v43
    v_exp_f32 v44, v44
    v_exp_f32 v45, v45
    v_exp_f32 v46, v46
    v_exp_f32 v47, v47
    v_exp_f32 v48, v48
    v_exp_f32 v49, v49
    v_smfmac_f32_32x32x32_bf16 v[16:31], v[196:199], v[40:47], v2
    v_exp_f32 v50, v50
    v_exp_f32 v51, v51
    v_exp_f32 v52, v52
    v_mfma_f32_32x32x16_bf16 v[32:47], v[104:107], v[12:15], 0
    v_exp_f32 v53, v53
    v_exp_f32 v54, v54
    v_exp_f32 v55, v55
    v_exp_f32 v56, v56
    v_exp_f32 v57, v57
    v_smfmac_f32_32x32x32_bf16 v[16:31], v[200:203], v[48:55], v2
    v_exp_f32 v58, v58
    v_exp_f32 v59, v59
    v_exp_f32 v60, v60
    v_exp_f32 v61, v61
    v_exp_f32 v62, v62
    v_exp_f32 v63, v63
    v_exp_f32 v32, v32
    v_exp_f32 v33, v33
    v_smfmac_f32_32x32x32_bf16 v[16:31], v[204:207], v[56:63], v2
    v_exp_f32 v34, v34
    v_exp_f32 v35, v35
    v_exp_f32 v36, v36
    v_mfma_f32_32x32x16_bf16 v[48:63], v[108:111], v[12:15], 0
    v_exp_f32 v37, v37
    v_exp_f32 v38, v38
    v_exp_f32 v39, v39
    v_exp_f32 v40, v40
    v_exp_f32 v41, v41
    v_smfmac_f32_32x32x32_bf16 v[16:31], v[208:211], v[32:39], v2
    v_exp_f32 v42, v42
    v_exp_f32 v43, v43
    v_exp_f32 v44, v44
    v_exp_f32 v45, v45
    v_exp_f32 v46, v46
    v_exp_f32 v47, v47
    v_exp_f32 v48, v48
    v_exp_f32 v49, v49
    v_smfmac_f32_32x32x32_bf16 v[16:31], v[212:215], v[40:47], v2
    v_exp_f32 v50, v50
    v_exp_f32 v51, v51
    v_exp_f32 v52, v52
    v_mfma_f32_32x32x16_bf16 v[32:47], v[112:115], v[12:15], 0
    v_exp_f32 v53, v53
    v_exp_f32 v54, v54
    v_exp_f32 v55, v55
    v_exp_f32 v56, v56
    v_exp_f32 v57, v57
    v_smfmac_f32_32x32x32_bf16 v[16:31], v[216:219], v[48:55], v2
    v_exp_f32 v58, v58
    v_exp_f32 v59, v59
    v_exp_f32 v60, v60
    v_exp_f32 v61, v61
    v_exp_f32 v62, v62
    v_exp_f32 v63, v63
    ds_read_b32 v6, v3 offset:3104
    ds_read_b128 v[8:11], v5 offset:2080
    v_exp_f32 v32, v32
    v_exp_f32 v33, v33
    v_smfmac_f32_32x32x32_bf16 v[16:31], v[220:223], v[56:63], v2
    v_exp_f32 v34, v34
    v_exp_f32 v35, v35
    v_exp_f32 v36, v36
    v_mfma_f32_32x32x16_bf16 v[48:63], v[116:119], v[12:15], 0
    v_exp_f32 v37, v37
    v_exp_f32 v38, v38
    v_exp_f32 v39, v39
    v_exp_f32 v40, v40
    v_exp_f32 v41, v41
    v_smfmac_f32_32x32x32_bf16 v[16:31], v[224:227], v[32:39], v2
    v_exp_f32 v42, v42
    v_exp_f32 v43, v43
    v_exp_f32 v44, v44
    v_exp_f32 v45, v45
    v_exp_f32 v46, v46
    v_exp_f32 v47, v47
    v_exp_f32 v48, v48
    v_exp_f32 v49, v49
    v_smfmac_f32_32x32x32_bf16 v[16:31], v[228:231], v[40:47], v2
    v_exp_f32 v50, v50
    v_exp_f32 v51, v51
    v_exp_f32 v52, v52
    v_mfma_f32_32x32x16_bf16 v[32:47], v[120:123], v[12:15], 0
    v_exp_f32 v53, v53
    v_exp_f32 v54, v54
    v_exp_f32 v55, v55
    v_exp_f32 v56, v56
    v_exp_f32 v57, v57
    v_smfmac_f32_32x32x32_bf16 v[16:31], v[232:235], v[48:55], v2
    v_exp_f32 v58, v58
    v_exp_f32 v59, v59
    s_waitcnt lgkmcnt(0)
    v_cmp_ne_u32 vcc, 4, v6
    v_exp_f32 v60, v60
    v_exp_f32 v61, v61
    v_exp_f32 v62, v62
    v_exp_f32 v63, v63
    s_cbranch_vccnz L_qretry_98
L_qok_99:
L_lb11_21:
    v_exp_f32 v32, v32
    v_exp_f32 v33, v33
    v_smfmac_f32_32x32x32_bf16 v[16:31], v[236:239], v[56:63], v2
    v_exp_f32 v34, v34
    v_exp_f32 v35, v35
    v_exp_f32 v36, v36
    v_mfma_f32_32x32x16_bf16 v[48:63], v[124:127], v[12:15], 0
    v_exp_f32 v37, v37
    v_exp_f32 v38, v38
    v_exp_f32 v39, v39
    v_exp_f32 v40, v40
    v_exp_f32 v41, v41
    v_smfmac_f32_32x32x32_bf16 v[16:31], v[240:243], v[32:39], v2
    v_exp_f32 v42, v42
    v_exp_f32 v43, v43
    v_exp_f32 v44, v44
    v_exp_f32 v45, v45
    v_exp_f32 v46, v46
    v_exp_f32 v47, v47
    v_exp_f32 v48, v48
    v_exp_f32 v49, v49
    v_smfmac_f32_32x32x32_bf16 v[16:31], v[244:247], v[40:47], v2
    v_exp_f32 v50, v50
    v_exp_f32 v51, v51
    v_exp_f32 v52, v52
    v_mfma_f32_32x32x16_bf16 v[32:47], v[64:67], v[8:11], 0
    v_exp_f32 v53, v53
    v_exp_f32 v54, v54
    v_exp_f32 v55, v55
    v_exp_f32 v56, v56
    v_exp_f32 v57, v57
    v_smfmac_f32_32x32x32_bf16 v[16:31], v[248:251], v[48:55], v2
    v_exp_f32 v58, v58
    v_exp_f32 v59, v59
    v_exp_f32 v60, v60
    v_exp_f32 v61, v61
    v_exp_f32 v62, v62
    v_exp_f32 v63, v63
    v_add_u32 v5, 2080, v5
    v_add_u32 v3, 2080, v3
    s_sub_u32 s12, s12, 1
    s_cbranch_scc0 L_cloop_10
    v_smfmac_f32_32x32x32_bf16 v[16:31], v[252:255], v[56:63], v2
    v_lshlrev_b32 v4, 4, v7
    v_add_u32 v4, s11, v4
    s_nop 9
    ds_write_b128 v4, v[16:19] offset:9216
    ds_write_b128 v4, v[20:23] offset:10240
    ds_write_addtid_b32 v24 offset:11264
    s_waitcnt lgkmcnt(0)
    s_barrier
    v_mov_b32 v0, v7
    s_branch L_epi_7
L_qretry_96:
    s_cmp_eq_u32 s13, 4
    s_cbranch_scc1 L_nopatch_100
    v_readfirstlane_b32 s4, v6
L_patch_24:
    s_sub_u32 s14, s14, 1
    s_cbranch_scc1 L_end_1
    v_lshrrev_b32 v1, 5, v7
    v_lshlrev_b32 v1, 4, v1
    v_and_b32 v6, 15, v7
    v_lshlrev_b32 v6, 1, v6
    ds_read_b32 v0, v0 offset:10592
    ds_read_u16 v6, v6 offset:10656
    s_mov_b64 exec, s[32:33]
    ds_read_b128 v[124:127], v1 offset:10624
    s_mov_b64 exec, -1
    v_mov_b32 v1, 0
    s_waitcnt lgkmcnt(0)
    v_cmp_ne_u32 vcc, s40, v0
    v_mov_b32 v0, 0
    s_cbranch_vccnz L_patch_24
    v_lshl_or_b32 v6, v6, 16, v6
    s_mov_b64 exec, s[34:35]
    v_bfi_b32 v248, s36, v6, v248
    v_bfi_b32 v249, s37, v6, v249
    v_bfi_b32 v250, s38, v6, v250
    v_bfi_b32 v251, s39, v6, v251
    v_bfi_b32 v252, s98, v6, v252
    v_bfi_b32 v253, s99, v6, v253
    v_bfi_b32 v254, s100, v6, v254
    v_bfi_b32 v255, s101, v6, v255
    s_mov_b64 exec, -1
    s_cmp_eq_u32 s13, 4
    s_cbranch_scc1 L_patchret_25
    s_mov_b32 s13, 4
    s_cmp_eq_u32 s4, 4
    s_cbranch_scc1 L_qok_97
L_nopatch_100:
    s_sub_u32 s14, s14, 1
    s_cbranch_scc1 L_end_1
    s_sleep 1
    ds_read_b32 v6, v3 offset:2064
    ds_read_b128 v[12:15], v5 offset:1040
    s_waitcnt lgkmcnt(0)
    v_readfirstlane_b32 s4, v6
    s_cmp_eq_u32 s4, 4
    s_cbranch_scc0 L_qretry_96
    s_branch L_qok_97
L_qretry_98:
    s_sub_u32 s14, s14, 1
    s_cbranch_scc1 L_end_1
    s_sleep 1
    ds_read_b32 v6, v3 offset:3104
    ds_read_b128 v[8:11], v5 offset:2080
    s_waitcnt lgkmcnt(0)
    v_readfirstlane_b32 s4, v6
    s_cmp_eq_u32 s4, 4
    s_cbranch_scc0 L_qretry_98
    s_branch L_qok_99
L_kvs_32:
    s_sub_u32 s14, s14, 1
    s_cbranch_scc1 L_end_1
    s_add_u32 s4, s10, 0
    s_and_b32 s4, s4, 0x3fff
    s_add_u32 s4, s4, s8
    buffer_load_dwordx4 v[64:67], v5, s[44:47], s4 offen sc1
    buffer_load_dwordx4 v[128:131], v4, s[44:47], s4 offen sc1
    s_waitcnt vmcnt(0)
    s_branch L_kvc_31
L_kvs_34:
    s_sub_u32 s14, s14, 1
    s_cbranch_scc1 L_end_1
    s_add_u32 s4, s10, 1024
    s_and_b32 s4, s4, 0x3fff
    s_add_u32 s4, s4, s8
    buffer_load_dwordx4 v[68:71], v5, s[44:47], s4 offen sc1
    buffer_load_dwordx4 v[136:139], v4, s[44:47], s4 offen sc1
    s_waitcnt vmcnt(0)
    s_branch L_kvc_33
L_kvs_36:
    s_sub_u32 s14, s14, 1
    s_cbranch_scc1 L_end_1
    s_add_u32 s4, s10, 2048
    s_and_b32 s4, s4, 0x3fff
    s_add_u32 s4, s4, s8
    buffer_load_dwordx4 v[72:75], v5, s[44:47], s4 offen sc1
    buffer_load_dwordx4 v[144:147], v4, s[44:47], s4 offen sc1
    s_waitcnt vmcnt(0)
    s_branch L_kvc_35
L_kvs_38:
    s_sub_u32 s14, s14, 1
    s_cbranch_scc1 L_end_1
    s_add_u32 s4, s10, 3072
    s_and_b32 s4, s4, 0x3fff
    s_add_u32 s4, s4, s8
    buffer_load_dwordx4 v[76:79], v5, s[44:47], s4 offen sc1
    buffer_load_dwordx4 v[152:155], v4, s[44:47], s4 offen sc1
    s_waitcnt vmcnt(0)
    s_branch L_kvc_37
L_kvs_40:
    s_sub_u32 s14, s14, 1
    s_cbranch_scc1 L_end_1
    s_add_u32 s4, s10, 4096
    s_and_b32 s4, s4, 0x3fff
    s_add_u32 s4, s4, s8
    buffer_load_dwordx4 v[80:83], v5, s[44:47], s4 offen sc1
    buffer_load_dwordx4 v[160:163], v4, s[44:47], s4 offen sc1
    s_waitcnt vmcnt(0)
    s_branch L_kvc_39
L_kvs_42:
    s_sub_u32 s14, s14, 1
    s_cbranch_scc1 L_end_1
    s_add_u32 s4, s10, 5120
    s_and_b32 s4, s4, 0x3fff
    s_add_u32 s4, s4, s8
    buffer_load_dwordx4 v[84:87], v5, s[44:47], s4 offen sc1
    buffer_load_dwordx4 v[168:171], v4, s[44:47], s4 offen sc1
    s_waitcnt vmcnt(0)
    s_branch L_kvc_41
L_kvs_44:
    s_sub_u32 s14, s14, 1
    s_cbranch_scc1 L_end_1
    s_add_u32 s4, s10, 6144
    s_and_b32 s4, s4, 0x3fff
    s_add_u32 s4, s4, s8
    buffer_load_dwordx4 v[88:91], v5, s[44:47], s4 offen sc1
    buffer_load_dwordx4 v[176:179], v4, s[44:47], s4 offen sc1
    s_waitcnt vmcnt(0)
    s_branch L_kvc_43
L_kvs_46:
    s_sub_u32 s14, s14, 1
    s_cbranch_scc1 L_end_1
    s_add_u32 s4, s10, 7168
    s_and_b32 s4, s4, 0x3fff
    s_add_u32 s4, s4, s8
    buffer_load_dwordx4 v[92:95], v5, s[44:47], s4 offen sc1
    buffer_load_dwordx4 v[184:187], v4, s[44:47], s4 offen sc1
    s_waitcnt vmcnt(0)
    s_branch L_kvc_45
L_kvs_48:
    s_sub_u32 s14, s14, 1
    s_cbranch_scc1 L_end_1
    s_add_u32 s4, s10, 8192
    s_and_b32 s4, s4, 0x3fff
    s_add_u32 s4, s4, s8
    buffer_load_dwordx4 v[96:99], v5, s[44:47], s4 offen sc1
    buffer_load_dwordx4 v[192:195], v4, s[44:47], s4 offen sc1
    s_waitcnt vmcnt(0)
    s_branch L_kvc_47
L_kvs_50:
    s_sub_u32 s14, s14, 1
    s_cbranch_scc1 L_end_1
    s_add_u32 s4, s10, 9216
    s_and_b32 s4, s4, 0x3fff
    s_add_u32 s4, s4, s8
    buffer_load_dwordx4 v[100:103], v5, s[44:47], s4 offen sc1
    buffer_load_dwordx4 v[200:203], v4, s[44:47], s4 offen sc1
    s_waitcnt vmcnt(0)
    s_branch L_kvc_49
L_kvs_52:
    s_sub_u32 s14, s14, 1
    s_cbranch_scc1 L_end_1
    s_add_u32 s4, s10, 10240
    s_and_b32 s4, s4, 0x3fff
    s_add_u32 s4, s4, s8
    buffer_load_dwordx4 v[104:107], v5, s[44:47], s4 offen sc1
    buffer_load_dwordx4 v[208:211], v4, s[44:47], s4 offen sc1
    s_waitcnt vmcnt(0)
    s_branch L_kvc_51
L_kvs_54:
    s_sub_u32 s14, s14, 1
    s_cbranch_scc1 L_end_1
    s_add_u32 s4, s10, 11264
    s_and_b32 s4, s4, 0x3fff
    s_add_u32 s4, s4, s8
    buffer_load_dwordx4 v[108:111], v5, s[44:47], s4 offen sc1
    buffer_load_dwordx4 v[216:219], v4, s[44:47], s4 offen sc1
    s_waitcnt vmcnt(0)
    s_branch L_kvc_53
L_kvs_56:
    s_sub_u32 s14, s14, 1
    s_cbranch_scc1 L_end_1
    s_add_u32 s4, s10, 12288
    s_and_b32 s4, s4, 0x3fff
    s_add_u32 s4, s4, s8
    buffer_load_dwordx4 v[112:115], v5, s[44:47], s4 offen sc1
    buffer_load_dwordx4 v[224:227], v4, s[44:47], s4 offen sc1
    s_waitcnt vmcnt(0)
    s_branch L_kvc_55
L_kvs_58:
    s_sub_u32 s14, s14, 1
    s_cbranch_scc1 L_end_1
    s_add_u32 s4, s10, 13312
    s_and_b32 s4, s4, 0x3fff
    s_add_u32 s4, s4, s8
    buffer_load_dwordx4 v[116:119], v5, s[44:47], s4 offen sc1
    buffer_load_dwordx4 v[232:235], v4, s[44:47], s4 offen sc1
    s_waitcnt vmcnt(0)
    s_branch L_kvc_57
L_kvs_60:
    s_sub_u32 s14, s14, 1
    s_cbranch_scc1 L_end_1
    s_add_u32 s4, s10, 14336
    s_and_b32 s4, s4, 0x3fff
    s_add_u32 s4, s4, s8
    buffer_load_dwordx4 v[120:123], v5, s[44:47], s4 offen sc1
    buffer_load_dwordx4 v[240:243], v4, s[44:47], s4 offen sc1
    s_waitcnt vmcnt(0)
    s_branch L_kvc_59
L_kvs_62:
    s_sub_u32 s14, s14, 1
    s_cbranch_scc1 L_end_1
    s_add_u32 s4, s10, 15360
    s_and_b32 s4, s4, 0x3fff
    s_add_u32 s4, s4, s8
    buffer_load_dwordx4 v[124:127], v5, s[44:47], s4 offen sc1
    buffer_load_dwordx4 v[248:251], v4, s[44:47], s4 offen sc1
    s_waitcnt vmcnt(0)
    s_branch L_kvc_61
L_kvs_64:
    s_sub_u32 s14, s14, 1
    s_cbranch_scc1 L_end_1
    s_add_u32 s4, s10, 0
    s_and_b32 s4, s4, 0x3fff
    s_add_u32 s4, s4, s8
    buffer_load_dwordx4 v[64:67], v5, s[44:47], s4 offen sc1
    buffer_load_dwordx4 v[128:131], v4, s[44:47], s4 offen sc1
    s_waitcnt vmcnt(0)
    s_branch L_kvc_63
L_kvs_66:
    s_sub_u32 s14, s14, 1
    s_cbranch_scc1 L_end_1
    s_add_u32 s4, s10, 1024
    s_and_b32 s4, s4, 0x3fff
    s_add_u32 s4, s4, s8
    buffer_load_dwordx4 v[68:71], v5, s[44:47], s4 offen sc1
    buffer_load_dwordx4 v[136:139], v4, s[44:47], s4 offen sc1
    s_waitcnt vmcnt(0)
    s_branch L_kvc_65
L_kvs_68:
    s_sub_u32 s14, s14, 1
    s_cbranch_scc1 L_end_1
    s_add_u32 s4, s10, 2048
    s_and_b32 s4, s4, 0x3fff
    s_add_u32 s4, s4, s8
    buffer_load_dwordx4 v[72:75], v5, s[44:47], s4 offen sc1
    buffer_load_dwordx4 v[144:147], v4, s[44:47], s4 offen sc1
    s_waitcnt vmcnt(0)
    s_branch L_kvc_67
L_kvs_70:
    s_sub_u32 s14, s14, 1
    s_cbranch_scc1 L_end_1
    s_add_u32 s4, s10, 3072
    s_and_b32 s4, s4, 0x3fff
    s_add_u32 s4, s4, s8
    buffer_load_dwordx4 v[76:79], v5, s[44:47], s4 offen sc1
    buffer_load_dwordx4 v[152:155], v4, s[44:47], s4 offen sc1
    s_waitcnt vmcnt(0)
    s_branch L_kvc_69
L_kvs_72:
    s_sub_u32 s14, s14, 1
    s_cbranch_scc1 L_end_1
    s_add_u32 s4, s10, 4096
    s_and_b32 s4, s4, 0x3fff
    s_add_u32 s4, s4, s8
    buffer_load_dwordx4 v[80:83], v5, s[44:47], s4 offen sc1
    buffer_load_dwordx4 v[160:163], v4, s[44:47], s4 offen sc1
    s_waitcnt vmcnt(0)
    s_branch L_kvc_71
L_kvs_74:
    s_sub_u32 s14, s14, 1
    s_cbranch_scc1 L_end_1
    s_add_u32 s4, s10, 5120
    s_and_b32 s4, s4, 0x3fff
    s_add_u32 s4, s4, s8
    buffer_load_dwordx4 v[84:87], v5, s[44:47], s4 offen sc1
    buffer_load_dwordx4 v[168:171], v4, s[44:47], s4 offen sc1
    s_waitcnt vmcnt(0)
    s_branch L_kvc_73
L_kvs_76:
    s_sub_u32 s14, s14, 1
    s_cbranch_scc1 L_end_1
    s_add_u32 s4, s10, 6144
    s_and_b32 s4, s4, 0x3fff
    s_add_u32 s4, s4, s8
    buffer_load_dwordx4 v[88:91], v5, s[44:47], s4 offen sc1
    buffer_load_dwordx4 v[176:179], v4, s[44:47], s4 offen sc1
    s_waitcnt vmcnt(0)
    s_branch L_kvc_75
L_kvs_78:
    s_sub_u32 s14, s14, 1
    s_cbranch_scc1 L_end_1
    s_add_u32 s4, s10, 7168
    s_and_b32 s4, s4, 0x3fff
    s_add_u32 s4, s4, s8
    buffer_load_dwordx4 v[92:95], v5, s[44:47], s4 offen sc1
    buffer_load_dwordx4 v[184:187], v4, s[44:47], s4 offen sc1
    s_waitcnt vmcnt(0)
    s_branch L_kvc_77
L_kvs_80:
    s_sub_u32 s14, s14, 1
    s_cbranch_scc1 L_end_1
    s_add_u32 s4, s10, 8192
    s_and_b32 s4, s4, 0x3fff
    s_add_u32 s4, s4, s8
    buffer_load_dwordx4 v[96:99], v5, s[44:47], s4 offen sc1
    buffer_load_dwordx4 v[192:195], v4, s[44:47], s4 offen sc1
    s_waitcnt vmcnt(0)
    s_branch L_kvc_79
L_kvs_82:
    s_sub_u32 s14, s14, 1
    s_cbranch_scc1 L_end_1
    s_add_u32 s4, s10, 9216
    s_and_b32 s4, s4, 0x3fff
    s_add_u32 s4, s4, s8
    buffer_load_dwordx4 v[100:103], v5, s[44:47], s4 offen sc1
    buffer_load_dwordx4 v[200:203], v4, s[44:47], s4 offen sc1
    s_waitcnt vmcnt(0)
    s_branch L_kvc_81
L_kvs_84:
    s_sub_u32 s14, s14, 1
    s_cbranch_scc1 L_end_1
    s_add_u32 s4, s10, 10240
    s_and_b32 s4, s4, 0x3fff
    s_add_u32 s4, s4, s8
    buffer_load_dwordx4 v[104:107], v5, s[44:47], s4 offen sc1
    buffer_load_dwordx4 v[208:211], v4, s[44:47], s4 offen sc1
    s_waitcnt vmcnt(0)
    s_branch L_kvc_83
L_kvs_86:
    s_sub_u32 s14, s14, 1
    s_cbranch_scc1 L_end_1
    s_add_u32 s4, s10, 11264
    s_and_b32 s4, s4, 0x3fff
    s_add_u32 s4, s4, s8
    buffer_load_dwordx4 v[108:111], v5, s[44:47], s4 offen sc1
    buffer_load_dwordx4 v[216:219], v4, s[44:47], s4 offen sc1
    s_waitcnt vmcnt(0)
    s_branch L_kvc_85
L_kvs_88:
    s_sub_u32 s14, s14, 1
    s_cbranch_scc1 L_end_1
    s_add_u32 s4, s10, 12288
    s_and_b32 s4, s4, 0x3fff
    s_add_u32 s4, s4, s8
    buffer_load_dwordx4 v[112:115], v5, s[44:47], s4 offen sc1
    buffer_load_dwordx4 v[224:227], v4, s[44:47], s4 offen sc1
    s_waitcnt vmcnt(0)
    s_branch L_kvc_87
L_kvs_90:
    s_sub_u32 s14, s14, 1
    s_cbranch_scc1 L_end_1
    s_add_u32 s4, s10, 13312
    s_and_b32 s4, s4, 0x3fff
    s_add_u32 s4, s4, s8
    buffer_load_dwordx4 v[116:119], v5, s[44:47], s4 offen sc1
    buffer_load_dwordx4 v[232:235], v4, s[44:47], s4 offen sc1
    s_waitcnt vmcnt(0)
    s_branch L_kvc_89
L_kvs_92:
    s_sub_u32 s14, s14, 1
    s_cbranch_scc1 L_end_1
    s_add_u32 s4, s10, 14336
    s_and_b32 s4, s4, 0x3fff
    s_add_u32 s4, s4, s8
    buffer_load_dwordx4 v[120:123], v5, s[44:47], s4 offen sc1
    buffer_load_dwordx4 v[240:243], v4, s[44:47], s4 offen sc1
    s_waitcnt vmcnt(0)
    s_branch L_kvc_91
L_kvs_94:
    s_sub_u32 s14, s14, 1
    s_cbranch_scc1 L_end_1
    s_add_u32 s4, s10, 15360
    s_and_b32 s4, s4, 0x3fff
    s_add_u32 s4, s4, s8
    buffer_load_dwordx4 v[124:127], v5, s[44:47], s4 offen sc1
    buffer_load_dwordx4 v[248:251], v4, s[44:47], s4 offen sc1
    s_waitcnt vmcnt(0)
    s_branch L_kvc_93
L_hstart_3:
    s_sub_u32 s9, s3, 4
    s_lshl_b32 s8, s9, 14
    s_mov_b32 s58, 0x4000
    s_mov_b32 s59, 0x00020000
    s_add_u32 s5, s8, 129024
    s_mov_b32 s4, 0
    s_waitcnt lgkmcnt(0)
    s_mov_b32 s44, s40
    s_mov_b32 s45, s41
    s_mov_b32 s46, 0x400000
    s_mov_b32 s47, 0x00020000
    s_mov_b32 s68, s18
    s_mov_b32 s69, s19
    s_mov_b32 s70, 0x80000
    s_mov_b32 s71, 0x00020000
    s_cmp_ge_u32 s3, 6
    s_cbranch_scc1 L_h67_101
    s_setprio 2
    s_cmp_eq_u32 s3, 4
    s_cselect_b32 s56, s20, s22
    s_cselect_b32 s57, s21, s23
    s_mov_b32 m0, s5
    s_add_u32 s5, s5, 4096
    buffer_load_dwordx4 v1, s[56:59], s4 offen offset:0 lds
    buffer_load_dwordx4 v1, s[56:59], s4 offen offset:1024 lds
    buffer_load_dwordx4 v1, s[56:59], s4 offen offset:2048 lds
    buffer_load_dwordx4 v1, s[56:59], s4 offen offset:3072 lds
    s_add_u32 s4, s4, 4096
    s_mov_b32 m0, s5
    s_add_u32 s5, s5, 4096
    buffer_load_dwordx4 v1, s[56:59], s4 offen offset:0 lds
    buffer_load_dwordx4 v1, s[56:59], s4 offen offset:1024 lds
    buffer_load_dwordx4 v1, s[56:59], s4 offen offset:2048 lds
    buffer_load_dwordx4 v1, s[56:59], s4 offen offset:3072 lds
    s_add_u32 s4, s4, 4096
    s_mov_b32 m0, s5
    s_add_u32 s5, s5, 4096
    buffer_load_dwordx4 v1, s[56:59], s4 offen offset:0 lds
    buffer_load_dwordx4 v1, s[56:59], s4 offen offset:1024 lds
    buffer_load_dwordx4 v1, s[56:59], s4 offen offset:2048 lds
    buffer_load_dwordx4 v1, s[56:59], s4 offen offset:3072 lds
    s_add_u32 s4, s4, 4096
    s_mov_b32 m0, s5
    s_add_u32 s5, s5, 4096
    buffer_load_dwordx4 v1, s[56:59], s4 offen offset:0 lds
    buffer_load_dwordx4 v1, s[56:59], s4 offen offset:1024 lds
    buffer_load_dwordx4 v1, s[56:59], s4 offen offset:2048 lds
    buffer_load_dwordx4 v1, s[56:59], s4 offen offset:3072 lds
    s_add_u32 s4, s4, 4096
    s_branch L_hcon_105
L_h67_101:
    v_lshlrev_b32 v8, 10, v0
    s_lshr_b32 s4, s2, 3
    s_lshl_b32 s4, s4, 1
    s_add_u32 s4, s4, s9
    s_sub_u32 s4, s4, 2
    s_lshl_b32 s4, s4, 13
    s_mov_b64 exec, 0xff
    buffer_load_dword v251, v8, s[68:71], s4 offen
    s_mov_b64 exec, -1
    s_bfe_u32 s11, s2, 0x30004
    s_and_b32 s10, s2, 15
    s_lshl_b32 s10, s10, 1
    s_and_b32 s12, s3, 1
    s_add_u32 s10, s10, s12
    v_bfe_u32 v8, v0, 5, 1
    v_lshlrev_b32 v8, 14, v8
    v_bfe_u32 v9, v0, 4, 1
    v_lshl_add_u32 v8, v9, 12, v8
    v_and_b32 v9, 15, v0
    v_lshl_add_u32 v8, v9, 1, v8
    s_lshl_b32 s4, s10, 14
    s_lshl_b32 s5, s11, 11
    s_add_u32 s4, s4, s5
    s_lshl_b32 s5, s11, 16
    s_lshl_b32 s12, s10, 11
    s_add_u32 s12, s12, s5
    s_add_u32 s12, s12, 0x80000
    s_cmp_lt_u32 s2, 128
    s_cselect_b32 s13, s4, s12
    s_cselect_b32 s48, s18, s24
    s_cselect_b32 s49, s19, s25
    s_mov_b32 s50, 0x80000
    s_mov_b32 s51, 0x00020000
    s_lshl_b32 s4, s10, 5
    s_add_u32 s4, s4, s5
    s_add_u32 s5, s4, 8192
    buffer_load_ushort v32, v8, s[48:51], s4 offen offset:0
    buffer_load_ushort v33, v8, s[48:51], s4 offen offset:1024
    buffer_load_ushort v34, v8, s[48:51], s5 offen offset:0
    buffer_load_ushort v35, v8, s[48:51], s5 offen offset:1024
    buffer_load_ushort v36, v8, s[48:51], s4 offen offset:2048
    buffer_load_ushort v37, v8, s[48:51], s4 offen offset:3072
    buffer_load_ushort v38, v8, s[48:51], s5 offen offset:2048
    buffer_load_ushort v39, v8, s[48:51], s5 offen offset:3072
    s_add_u32 s4, s4, 0x8000
    s_add_u32 s5, s5, 0x8000
    buffer_load_ushort v40, v8, s[48:51], s4 offen offset:0
    buffer_load_ushort v41, v8, s[48:51], s4 offen offset:1024
    buffer_load_ushort v42, v8, s[48:51], s5 offen offset:0
    buffer_load_ushort v43, v8, s[48:51], s5 offen offset:1024
    buffer_load_ushort v44, v8, s[48:51], s4 offen offset:2048
    buffer_load_ushort v45, v8, s[48:51], s4 offen offset:3072
    buffer_load_ushort v46, v8, s[48:51], s5 offen offset:2048
    buffer_load_ushort v47, v8, s[48:51], s5 offen offset:3072
    s_cmp_eq_u32 s3, 7
    s_cbranch_scc1 L_hcon_105
    v_lshrrev_b32 v8, 1, v0
    v_cmp_lt_u32 vcc, 2, v8
    v_lshlrev_b32 v8, 14, v8
    s_lshl_b32 s4, s2, 6
    v_cndmask_b32 v28, 0, -1, vcc
    v_cndmask_b32 v29, 0, -1, vcc
    v_cndmask_b32 v30, 0, -1, vcc
    v_cndmask_b32 v31, 0, -1, vcc
    s_add_u32 s4, s4, 0x240000
    s_mul_i32 s5, s2, 48
    s_mov_b64 exec, 0x140
    v_subrev_u32 v8, s5, v8
    s_mov_b64 exec, 0x1555
    buffer_store_dwordx4 v[28:31], v8, s[44:47], s4 offen sc1
    s_mov_b64 exec, -1
L_hcon_105:
    s_mov_b32 s52, s36
    s_mov_b32 s53, s37
    s_mov_b32 s54, 0x200000
    s_mov_b32 s55, 0x00020000
    s_mov_b32 s60, s28
    s_mov_b32 s61, s29
    s_mov_b32 s62, 0x400
    s_mov_b32 s63, 0x00020000
    s_mov_b32 s72, s38
    s_mov_b32 s73, s39
    s_mov_b32 s74, 0x100
    s_mov_b32 s75, 0x00020000
    s_mov_b32 s48, s34
    s_mov_b32 s49, s35
    s_mov_b32 s50, 0x1c0000
    s_mov_b32 s51, 0x00020000
    s_cmp_eq_u32 s3, 6
    s_cselect_b32 s56, s30, s32
    s_cselect_b32 s57, s31, s33
    s_mov_b32 s58, 1835008
    s_mov_b32 s59, 0x00020000
    s_cmp_lt_u32 s3, 6
    s_cselect_b32 s64, s30, s32
    s_cselect_b32 s65, s31, s33
    s_cmp_ge_u32 s2, 224
    s_cselect_b32 s64, s34, s64
    s_cselect_b32 s65, s35, s65
    s_mov_b32 s66, 1835008
    s_mov_b32 s67, 0x00020000
    v_lshrrev_b32 v16, 1, v0
    v_lshlrev_b32 v16, 10, v16
    v_and_b32 v17, 1, v0
    v_lshl_add_u32 v16, v17, 4, v16
    v_mul_u32_u24 v15, 3584, v0
    s_and_b32 s4, s9, 1
    s_mul_i32 s4, s4, 917504
    s_lshl_b32 s5, s43, 4
    s_add_u32 s4, s4, s5
    s_mul_i32 s5, s9, 458752
    s_lshl_b32 s10, s43, 5
    s_add_u32 s5, s5, s10
    s_lshl_b32 s10, s9, 12
    s_mul_i32 s11, s9, 14336
    s_mov_b32 s12, 229376
    s_cmp_lg_u32 s96, 0
    s_cselect_b32 s98, s5, s4
    s_cselect_b32 s99, 0x8000, s12
    s_cselect_b32 s100, s11, s10
    s_cselect_b32 s101, 14, 4
    s_cselect_b64 vcc, -1, 0
    v_cndmask_b32 v15, v15, v16, vcc
    s_add_u32 s100, s100, 63488
    v_mov_b32 v10, 0
    v_mov_b32 v11, 0
    v_mov_b32 v9, 1
    v_lshrrev_b32 v16, 3, v0
    v_mul_u32_u24 v8, 1056, v16
    v_and_b32 v16, 7, v0
    v_lshl_add_u32 v8, v16, 2, v8
    s_lshl_b32 s4, s9, 5
    s_add_u32 s4, s4, 29184
    v_add_u32 v8, s4, v8
    v_and_b32 v16, 1, v0
    v_mul_u32_u24 v2, 0xaaaa, v16
    v_add_u32 v2, 0x4444, v2
    v_lshrrev_b32 v3, 4, v0
    v_and_b32 v16, 1, v0
    v_lshl_add_u32 v3, v3, 1, v16
    v_lshlrev_b32 v3, 4, v3
    v_bfe_u32 v16, v0, 1, 3
    v_mul_u32_u24 v16, 1056, v16
    v_add_u32 v3, v3, v16
    v_add_u32 v4, 29184, v3
    v_add_u32 v3, 12288, v3
    v_bfe_u32 v5, v0, 3, 1
    v_lshlrev_b32 v5, 9, v5
    v_and_b32 v16, 7, v0
    v_lshl_add_u32 v5, v16, 1, v5
    v_lshrrev_b32 v16, 4, v0
    v_lshl_add_u32 v5, v16, 5, v5
    s_lshl_b32 s4, s9, 7
    v_add_u32 v5, s4, v5
    v_lshrrev_b32 v16, 3, v0
    s_lshl_b32 s4, s9, 3
    v_add_u32 v17, s4, v16
    v_bfe_u32 v18, v0, 2, 1
    v_lshlrev_b32 v6, 10, v18
    v_bfe_u32 v18, v0, 1, 1
    v_lshl_add_u32 v6, v18, 7, v6
    v_lshl_add_u32 v6, v17, 2, v6
    v_and_b32 v18, 1, v0
    v_lshl_add_u32 v6, v18, 9, v6
    v_add_u32 v6, 45056, v6
    v_and_b32 v18, 3, v0
    v_mul_u32_u24 v7, 2304, v18
    v_lshl_add_u32 v7, v17, 2, v7
    v_add_u32 v7, 47104, v7
    v_mov_b32 v16, -1.0
    ds_write_b32 v7, v16
    ds_write_b32 v7, v16 offset:9216
    s_cmp_ge_u32 s3, 6
    s_cbranch_scc1 L_nokv0_107
    v_bfe_u32 v14, v0, 2, 1
    v_bfe_u32 v16, v0, 3, 1
    v_lshl_add_u32 v14, v16, 3, v14
    v_bfe_u32 v16, v0, 4, 1
    v_lshl_add_u32 v14, v16, 2, v14
    v_bfe_u32 v16, v0, 5, 1
    v_lshl_add_u32 v14, v16, 4, v14
    v_lshlrev_b32 v14, 5, v14
    v_and_b32 v16, 3, v0
    v_lshl_add_u32 v14, v16, 3, v14
    s_add_u32 s5, s8, 129024
    v_add_u32 v14, s5, v14
    s_lshl_b32 s4, s9, 8
    s_add_u32 s4, s4, 11776
    v_lshrrev_b32 v17, 4, v0
    v_bfe_u32 v16, v0, 3, 1
    v_lshlrev_b32 v20, 7, v16
    v_lshl_add_u32 v20, v17, 5, v20
    v_and_b32 v18, 7, v0
    v_lshl_add_u32 v20, v18, 1, v20
    v_lshlrev_b32 v23, 9, v16
    v_lshl_add_u32 v23, v18, 4, v23
    v_and_b32 v18, 15, v0
    v_lshlrev_b32 v18, 4, v18
    v_lshl_add_u32 v19, v17, 2, v18
    s_cmp_eq_u32 s3, 4
    s_cselect_b64 vcc, -1, 0
    s_cselect_b32 s5, 16, 2
    v_cndmask_b32 v20, v19, v20, vcc
    v_cndmask_b32 v23, v18, v23, vcc
    v_add_u32 v20, s4, v20
    v_add_u32 v21, s5, v20
    v_add_u32 v22, s4, v18
    s_waitcnt vmcnt(0)
    ds_read_b64_tr_b16 v[64:65], v14 offset:0
    ds_read_b64_tr_b16 v[66:67], v14 offset:64
    ds_read_b64_tr_b16 v[68:69], v14 offset:1024
    ds_read_b64_tr_b16 v[70:71], v14 offset:1088
    ds_read_b64_tr_b16 v[72:73], v14 offset:2048
    ds_read_b64_tr_b16 v[74:75], v14 offset:2112
    ds_read_b64_tr_b16 v[76:77], v14 offset:3072
    ds_read_b64_tr_b16 v[78:79], v14 offset:3136
    ds_read_b64_tr_b16 v[80:81], v14 offset:4096
    ds_read_b64_tr_b16 v[82:83], v14 offset:4160
    ds_read_b64_tr_b16 v[84:85], v14 offset:5120
    ds_read_b64_tr_b16 v[86:87], v14 offset:5184
    ds_read_b64_tr_b16 v[88:89], v14 offset:6144
    ds_read_b64_tr_b16 v[90:91], v14 offset:6208
    ds_read_b64_tr_b16 v[92:93], v14 offset:7168
    ds_read_b64_tr_b16 v[94:95], v14 offset:7232
    ds_read_b64_tr_b16 v[96:97], v14 offset:8192
    ds_read_b64_tr_b16 v[98:99], v14 offset:8256
    ds_read_b64_tr_b16 v[100:101], v14 offset:9216
    ds_read_b64_tr_b16 v[102:103], v14 offset:9280
    ds_read_b64_tr_b16 v[104:105], v14 offset:10240
    ds_read_b64_tr_b16 v[106:107], v14 offset:10304
    ds_read_b64_tr_b16 v[108:109], v14 offset:11264
    ds_read_b64_tr_b16 v[110:111], v14 offset:11328
    ds_read_b64_tr_b16 v[112:113], v14 offset:12288
    ds_read_b64_tr_b16 v[114:115], v14 offset:12352
    ds_read_b64_tr_b16 v[116:117], v14 offset:13312
    ds_read_b64_tr_b16 v[118:119], v14 offset:13376
    ds_read_b64_tr_b16 v[120:121], v14 offset:14336
    ds_read_b64_tr_b16 v[122:123], v14 offset:14400
    ds_read_b64_tr_b16 v[124:125], v14 offset:15360
    ds_read_b64_tr_b16 v[126:127], v14 offset:15424
    v_mov_b32 v16, 0
L_lw_109:
    s_sub_u32 s14, s14, 1
    s_cbranch_scc1 L_end_1
    ds_read_b32 v17, v16 offset:10588
    s_waitcnt lgkmcnt(0)
    v_cmp_ne_u32 vcc, 4, v17
    s_cbranch_vccnz L_lw_109
    ds_read_b128 v[32:35], v3 offset:0
    ds_read_b128 v[36:39], v3 offset:128
    ds_read_b128 v[40:43], v3 offset:256
    ds_read_b128 v[44:47], v3 offset:384
    ds_read_b128 v[48:51], v3 offset:512
    ds_read_b128 v[52:55], v3 offset:640
    ds_read_b128 v[56:59], v3 offset:768
    ds_read_b128 v[60:63], v3 offset:896
    v_mov_b32 v28, 0
    v_mov_b32 v29, 0
    v_mov_b32 v30, 0
    v_mov_b32 v31, 0
    s_cmp_eq_u32 s3, 4
    s_cselect_b32 s10, 0x3eb8aa3b, 1.0
    s_waitcnt lgkmcnt(7)
    v_smfmac_f32_16x16x64_bf16 v[28:31], v[32:35], v[64:71], v2
    s_waitcnt lgkmcnt(6)
    v_smfmac_f32_16x16x64_bf16 v[28:31], v[36:39], v[72:79], v2
    s_waitcnt lgkmcnt(5)
    v_smfmac_f32_16x16x64_bf16 v[28:31], v[40:43], v[80:87], v2
    s_waitcnt lgkmcnt(4)
    v_smfmac_f32_16x16x64_bf16 v[28:31], v[44:47], v[88:95], v2
    s_waitcnt lgkmcnt(3)
    v_smfmac_f32_16x16x64_bf16 v[28:31], v[48:51], v[96:103], v2
    s_waitcnt lgkmcnt(2)
    v_smfmac_f32_16x16x64_bf16 v[28:31], v[52:55], v[104:111], v2
    s_waitcnt lgkmcnt(1)
    v_smfmac_f32_16x16x64_bf16 v[28:31], v[56:59], v[112:119], v2
    s_waitcnt lgkmcnt(0)
    v_smfmac_f32_16x16x64_bf16 v[28:31], v[60:63], v[120:127], v2
    s_nop 7
    v_add_f32 v28, v28, v29
    v_add_f32 v30, v30, v31
    v_mul_f32 v28, s10, v28
    v_mul_f32 v30, s10, v30
    v_cvt_pk_bf16_f32 v28, v28, v30
    ds_write_b16 v20, v28
    ds_write_b16_d16_hi v21, v28
    ds_read_b128 v[16:19], v22
    s_lshr_b32 s4, s2, 2
    s_lshl_b32 s4, s4, 10
    s_and_b32 s5, s2, 3
    s_lshl_b32 s5, s5, 7
    s_add_u32 s4, s4, s5
    s_lshl_b32 s5, s2, 8
    s_add_u32 s5, s5, 0x10000
    s_cmp_eq_u32 s3, 4
    s_cselect_b32 s4, s4, s5
    s_add_u32 s4, s4, 0x100000
    s_mov_b64 exec, 0xffff
    s_waitcnt lgkmcnt(0)
    v_min_u32 v16, -2, v16
    v_min_u32 v17, -2, v17
    v_min_u32 v18, -2, v18
    v_min_u32 v19, -2, v19
    buffer_store_dwordx4 v[16:19], v23, s[44:47], s4 offen sc1
    v_mov_b32 v64, -1
    v_mov_b32 v65, -1
    v_mov_b32 v66, -1
    v_mov_b32 v67, -1
    s_add_u32 s4, s4, 0x20000
    buffer_store_dwordx4 v[64:67], v23, s[44:47], s4 offen sc1
    s_mov_b64 exec, -1
    v_mov_b32 v24, 0
    v_mov_b32 v25, 1
    s_waitcnt vmcnt(0)
    s_mov_b64 exec, 1
    ds_add_rtn_u32 v26, v24, v25 offset:10564
    s_waitcnt lgkmcnt(0)
    v_readfirstlane_b32 s5, v26
    s_cmp_lg_u32 s5, 3
    s_cbranch_scc1 L_npub_110
    s_lshl_b32 s4, s2, 6
    s_add_u32 s4, s4, 0x260000
    buffer_store_dword v25, off, s[44:47], s4 sc1
    ds_add_u32 v24, v25 offset:10564
L_npub_110:
    s_mov_b64 exec, -1
    s_branch L_hq0_104
L_nokv0_107:
    s_setprio 2
    s_waitcnt vmcnt(0)
    v_lshl_or_b32 v32, v33, 16, v32
    v_lshl_or_b32 v33, v35, 16, v34
    v_lshl_or_b32 v34, v37, 16, v36
    v_lshl_or_b32 v35, v39, 16, v38
    v_lshl_or_b32 v36, v41, 16, v40
    v_lshl_or_b32 v37, v43, 16, v42
    v_lshl_or_b32 v38, v45, 16, v44
    v_lshl_or_b32 v39, v47, 16, v46
    buffer_store_dwordx4 v[32:35], v1, s[44:47], s13 offen sc1
    buffer_store_dwordx4 v[36:39], v1, s[44:47], s13 offen offset:1024 sc1
    s_cmp_eq_u32 s3, 7
    s_cbranch_scc1 L_kvd0_108
L_winit_111:
    s_sub_u32 s14, s14, 1
    s_cbranch_scc1 L_end_1
    buffer_load_dword v16, off, s[72:75], 0 sc1
    s_waitcnt vmcnt(0)
    v_cmp_eq_u32 vcc, 0, v16
    s_cbranch_vccnz L_winit_111
L_kvd0_108:
    v_mov_b32 v16, 0
    v_mov_b32 v17, 1
    s_waitcnt vmcnt(0)
    s_mov_b64 exec, 1
    ds_add_rtn_u32 v18, v16, v17 offset:10564
    s_waitcnt lgkmcnt(0)
    v_readfirstlane_b32 s5, v18
    s_cmp_lg_u32 s5, 3
    s_cbranch_scc1 L_npub_112
    s_lshl_b32 s4, s2, 6
    s_add_u32 s4, s4, 0x260000
    buffer_store_dword v17, off, s[44:47], s4 sc1
    ds_add_u32 v16, v17 offset:10564
L_npub_112:
    s_mov_b64 exec, -1
L_hq0_104:
    v_bfe_u32 v22, v0, 2, 1
    v_bfe_u32 v23, v0, 3, 1
    v_lshl_add_u32 v22, v23, 3, v22
    v_bfe_u32 v23, v0, 4, 1
    v_lshl_add_u32 v22, v23, 2, v22
    v_bfe_u32 v23, v0, 5, 1
    v_lshl_add_u32 v22, v23, 4, v22
    v_lshlrev_b32 v22, 7, v22
    v_bfe_u32 v23, v0, 4, 1
    v_bfe_u32 v24, v0, 3, 1
    v_lshl_add_u32 v23, v24, 1, v23
    v_xor_b32 v23, s9, v23
    v_lshl_add_u32 v22, v23, 5, v22
    v_and_b32 v23, 3, v0
    v_lshl_add_u32 v22, v23, 3, v22
    v_add_u32 v22, 63488, v22
    v_mov_b32 v16, 0
L_lw_113:
    s_sub_u32 s14, s14, 1
    s_cbranch_scc1 L_end_1
    s_sleep 1
    ds_read_b32 v17, v16 offset:10580
    s_waitcnt lgkmcnt(0)
    v_cmp_ne_u32 vcc, 4, v17
    s_cbranch_vccnz L_lw_113
    ds_read_b64_tr_b16 v[128:129], v22 offset:0
    ds_read_b64_tr_b16 v[130:131], v22 offset:256
    ds_read_b64_tr_b16 v[132:133], v22 offset:4096
    ds_read_b64_tr_b16 v[134:135], v22 offset:4352
    ds_read_b64_tr_b16 v[136:137], v22 offset:8192
    ds_read_b64_tr_b16 v[138:139], v22 offset:8448
    ds_read_b64_tr_b16 v[140:141], v22 offset:12288
    ds_read_b64_tr_b16 v[142:143], v22 offset:12544
    ds_read_b64_tr_b16 v[144:145], v22 offset:16384
    ds_read_b64_tr_b16 v[146:147], v22 offset:16640
    ds_read_b64_tr_b16 v[148:149], v22 offset:20480
    ds_read_b64_tr_b16 v[150:151], v22 offset:20736
    ds_read_b64_tr_b16 v[152:153], v22 offset:24576
    ds_read_b64_tr_b16 v[154:155], v22 offset:24832
    ds_read_b64_tr_b16 v[156:157], v22 offset:28672
    ds_read_b64_tr_b16 v[158:159], v22 offset:28928
    ds_read_b64_tr_b16 v[160:161], v22 offset:32768
    ds_read_b64_tr_b16 v[162:163], v22 offset:33024
    ds_read_b64_tr_b16 v[164:165], v22 offset:36864
    ds_read_b64_tr_b16 v[166:167], v22 offset:37120
    ds_read_b64_tr_b16 v[168:169], v22 offset:40960
    ds_read_b64_tr_b16 v[170:171], v22 offset:41216
    ds_read_b64_tr_b16 v[172:173], v22 offset:45056
    ds_read_b64_tr_b16 v[174:175], v22 offset:45312
    ds_read_b64_tr_b16 v[176:177], v22 offset:49152
    ds_read_b64_tr_b16 v[178:179], v22 offset:49408
    ds_read_b64_tr_b16 v[180:181], v22 offset:53248
    ds_read_b64_tr_b16 v[182:183], v22 offset:53504
    ds_read_b64_tr_b16 v[184:185], v22 offset:57344
    ds_read_b64_tr_b16 v[186:187], v22 offset:57600
    ds_read_b64_tr_b16 v[188:189], v22 offset:61440
    ds_read_b64_tr_b16 v[190:191], v22 offset:61696
    s_mov_b32 s97, 0
L_hq_5:
    ds_read_b128 v[32:35], v3 offset:0
    ds_read_b128 v[36:39], v3 offset:128
    ds_read_b128 v[40:43], v3 offset:256
    ds_read_b128 v[44:47], v3 offset:384
    ds_read_b128 v[48:51], v3 offset:512
    ds_read_b128 v[52:55], v3 offset:640
    ds_read_b128 v[56:59], v3 offset:768
    ds_read_b128 v[60:63], v3 offset:896
    s_waitcnt lgkmcnt(0)
    v_mfma_f32_16x16x16_bf16 v[28:31], v[10:11], v[10:11], 0
    s_waitcnt vmcnt(0)
    s_nop 4
    v_smfmac_f32_16x16x64_bf16 v[28:31], v[32:35], v[128:135], v2
    v_smfmac_f32_16x16x64_bf16 v[28:31], v[36:39], v[136:143], v2
    v_smfmac_f32_16x16x64_bf16 v[28:31], v[40:43], v[144:151], v2
    v_smfmac_f32_16x16x64_bf16 v[28:31], v[44:47], v[152:159], v2
    v_smfmac_f32_16x16x64_bf16 v[28:31], v[48:51], v[160:167], v2
    v_smfmac_f32_16x16x64_bf16 v[28:31], v[52:55], v[168:175], v2
    v_smfmac_f32_16x16x64_bf16 v[28:31], v[56:59], v[176:183], v2
    v_smfmac_f32_16x16x64_bf16 v[28:31], v[60:63], v[184:191], v2
    s_nop 7
    v_add_f32 v28, v28, v29
    v_add_f32 v30, v30, v31
    v_cvt_pk_bf16_f32 v28, v28, v30
    ds_write_b16 v5, v28 offset:0
    ds_write_b16_d16_hi v5, v28 offset:16
    s_mov_b64 exec, 1
    ds_add_u32 v10, v9 offset:1024
    s_mov_b64 exec, -1
L_htop_6:
    v_mov_b32 v12, 0
    v_mov_b32 v13, 1.0
    v_mov_b32 v96, -1.0
    s_lshl_b32 s4, s15, 2
    s_add_u32 s4, s4, 4
    v_mov_b32 v16, 0
L_lw_115:
    s_sub_u32 s14, s14, 1
    s_cbranch_scc1 L_end_1
    s_sleep 1
    ds_read_b32 v17, v16 offset:10568
    s_waitcnt lgkmcnt(0)
    v_cmp_ne_u32 vcc, s4, v17
    s_cbranch_vccnz L_lw_115
    s_add_u32 s4, s8, 0x10000
    buffer_load_dwordx4 v[192:195], v1, s[44:47], s4 offen offset:0 sc1
    buffer_load_dwordx4 v[196:199], v1, s[44:47], s4 offen offset:1024 sc1
    buffer_load_dwordx4 v[200:203], v1, s[44:47], s4 offen offset:2048 sc1
    buffer_load_dwordx4 v[204:207], v1, s[44:47], s4 offen offset:3072 sc1
    s_add_u32 s4, s4, 4096
    buffer_load_dwordx4 v[208:211], v1, s[44:47], s4 offen offset:0 sc1
    buffer_load_dwordx4 v[212:215], v1, s[44:47], s4 offen offset:1024 sc1
    buffer_load_dwordx4 v[216:219], v1, s[44:47], s4 offen offset:2048 sc1
    buffer_load_dwordx4 v[220:223], v1, s[44:47], s4 offen offset:3072 sc1
    s_add_u32 s4, s4, 4096
    buffer_load_dwordx4 v[224:227], v1, s[44:47], s4 offen offset:0 sc1
    buffer_load_dwordx4 v[228:231], v1, s[44:47], s4 offen offset:1024 sc1
    buffer_load_dwordx4 v[232:235], v1, s[44:47], s4 offen offset:2048 sc1
    buffer_load_dwordx4 v[236:239], v1, s[44:47], s4 offen offset:3072 sc1
    s_add_u32 s4, s4, 4096
    buffer_load_dwordx4 v[240:243], v1, s[44:47], s4 offen offset:0 sc1
    buffer_load_dwordx4 v[244:247], v1, s[44:47], s4 offen offset:1024 sc1
    buffer_load_dwordx4 v[248:251], v1, s[44:47], s4 offen offset:2048 sc1
    buffer_load_dwordx4 v[252:255], v1, s[44:47], s4 offen offset:3072 sc1
    v_mov_b32 v64, 0
    v_mov_b32 v65, 0
    v_mov_b32 v66, 0
    v_mov_b32 v67, 0
    v_mov_b32 v68, 0
    v_mov_b32 v69, 0
    v_mov_b32 v70, 0
    v_mov_b32 v71, 0
    v_mov_b32 v72, 0
    v_mov_b32 v73, 0
    v_mov_b32 v74, 0
    v_mov_b32 v75, 0
    v_mov_b32 v76, 0
    v_mov_b32 v77, 0
    v_mov_b32 v78, 0
    v_mov_b32 v79, 0
    v_mov_b32 v80, 0
    v_mov_b32 v81, 0
    v_mov_b32 v82, 0
    v_mov_b32 v83, 0
    v_mov_b32 v84, 0
    v_mov_b32 v85, 0
    v_mov_b32 v86, 0
    v_mov_b32 v87, 0
    v_mov_b32 v88, 0
    v_mov_b32 v89, 0
    v_mov_b32 v90, 0
    v_mov_b32 v91, 0
    v_mov_b32 v92, 0
    v_mov_b32 v93, 0
    v_mov_b32 v94, 0
    v_mov_b32 v95, 0
    v_mfma_f32_16x16x16_bf16 v[28:31], v[10:11], v[10:11], 0
    s_waitcnt vmcnt(0)
    s_nop 4
    v_smfmac_f32_16x16x64_bf16 v[28:31], v[32:35], v[192:199], v2
    v_smfmac_f32_16x16x64_bf16 v[28:31], v[36:39], v[200:207], v2
    v_smfmac_f32_16x16x64_bf16 v[28:31], v[40:43], v[208:215], v2
    v_smfmac_f32_16x16x64_bf16 v[28:31], v[44:47], v[216:223], v2
    v_smfmac_f32_16x16x64_bf16 v[28:31], v[48:51], v[224:231], v2
    v_smfmac_f32_16x16x64_bf16 v[28:31], v[52:55], v[232:239], v2
    v_smfmac_f32_16x16x64_bf16 v[28:31], v[56:59], v[240:247], v2
    v_smfmac_f32_16x16x64_bf16 v[28:31], v[60:63], v[248:255], v2
    s_nop 7
    v_add_f32 v28, v28, v29
    v_add_f32 v30, v30, v31
    v_cvt_pk_bf16_f32 v28, v28, v30
    ds_write_b16 v5, v28 offset:1040
    ds_write_b16_d16_hi v5, v28 offset:1056
    s_mov_b64 exec, 1
    ds_add_u32 v10, v9 offset:2064
    s_mov_b64 exec, -1
    s_add_u32 s4, s8, 0x20000
    buffer_load_dwordx4 v[128:131], v1, s[44:47], s4 offen offset:0 sc1
    buffer_load_dwordx4 v[132:135], v1, s[44:47], s4 offen offset:1024 sc1
    buffer_load_dwordx4 v[136:139], v1, s[44:47], s4 offen offset:2048 sc1
    buffer_load_dwordx4 v[140:143], v1, s[44:47], s4 offen offset:3072 sc1
    s_add_u32 s4, s4, 4096
    buffer_load_dwordx4 v[144:147], v1, s[44:47], s4 offen offset:0 sc1
    buffer_load_dwordx4 v[148:151], v1, s[44:47], s4 offen offset:1024 sc1
    buffer_load_dwordx4 v[152:155], v1, s[44:47], s4 offen offset:2048 sc1
    buffer_load_dwordx4 v[156:159], v1, s[44:47], s4 offen offset:3072 sc1
    s_add_u32 s4, s4, 4096
    buffer_load_dwordx4 v[160:163], v1, s[44:47], s4 offen offset:0 sc1
    buffer_load_dwordx4 v[164:167], v1, s[44:47], s4 offen offset:1024 sc1
    buffer_load_dwordx4 v[168:171], v1, s[44:47], s4 offen offset:2048 sc1
    buffer_load_dwordx4 v[172:175], v1, s[44:47], s4 offen offset:3072 sc1
    s_add_u32 s4, s4, 4096
    buffer_load_dwordx4 v[176:179], v1, s[44:47], s4 offen offset:0 sc1
    buffer_load_dwordx4 v[180:183], v1, s[44:47], s4 offen offset:1024 sc1
    buffer_load_dwordx4 v[184:187], v1, s[44:47], s4 offen offset:2048 sc1
    buffer_load_dwordx4 v[188:191], v1, s[44:47], s4 offen offset:3072 sc1
    s_cmp_eq_u32 s97, 0
    s_cbranch_scc1 L_hk2_116
    v_and_b32 v16, 3, v0
    v_lshlrev_b32 v17, 4, v16
    v_lshlrev_b32 v16, 6, v16
    v_mov_b32 v19, 2
    s_mov_b32 s4, 0x258000
    s_mov_b64 vcc, -1
L_p3_117:
    s_sub_u32 s14, s14, 1
    s_cbranch_scc1 L_end_1
    s_sleep 1
    s_mov_b64 exec, vcc
    buffer_load_dwordx4 v[28:31], v16, s[44:47], s4 offen sc1
    s_waitcnt vmcnt(0)
    v_max3_u32 v18, v28, v29, v30
    v_max_u32 v18, v31, v18
    v_cmp_eq_u32 vcc, -1, v18
    s_cbranch_vccnz L_p3_117
    s_mov_b64 exec, -1
    s_mov_b64 exec, 15
    ds_write_b128 v17, v[28:31] offset:10624
    s_mov_b64 exec, 1
    ds_add_u32 v10, v19 offset:10592
    s_mov_b64 exec, -1
L_hk2_116:
    s_lshl_b32 s4, s15, 1
    v_mov_b32 v16, 0
    s_branch L_lw_119x
L_lw_119:
    s_sub_u32 s14, s14, 1
    s_cbranch_scc1 L_end_1
    s_sleep 3
L_lw_119x:
    ds_read_b32 v17, v16 offset:10592
    s_waitcnt lgkmcnt(0)
    v_cmp_ne_u32 vcc, s4, v17
    s_cbranch_vccnz L_lw_119
    s_add_u32 s4, s8, 0x80000
    buffer_load_dwordx4 v[192:195], v1, s[44:47], s4 offen offset:0 sc1
    buffer_load_dwordx4 v[196:199], v1, s[44:47], s4 offen offset:1024 sc1
    buffer_load_dwordx4 v[200:203], v1, s[44:47], s4 offen offset:2048 sc1
    buffer_load_dwordx4 v[204:207], v1, s[44:47], s4 offen offset:3072 sc1
    s_add_u32 s4, s4, 4096
    buffer_load_dwordx4 v[208:211], v1, s[44:47], s4 offen offset:0 sc1
    buffer_load_dwordx4 v[212:215], v1, s[44:47], s4 offen offset:1024 sc1
    buffer_load_dwordx4 v[216:219], v1, s[44:47], s4 offen offset:2048 sc1
    buffer_load_dwordx4 v[220:223], v1, s[44:47], s4 offen offset:3072 sc1
    s_add_u32 s4, s4, 4096
    buffer_load_dwordx4 v[224:227], v1, s[44:47], s4 offen offset:0 sc1
    buffer_load_dwordx4 v[228:231], v1, s[44:47], s4 offen offset:1024 sc1
    buffer_load_dwordx4 v[232:235], v1, s[44:47], s4 offen offset:2048 sc1
    buffer_load_dwordx4 v[236:239], v1, s[44:47], s4 offen offset:3072 sc1
    s_add_u32 s4, s4, 4096
    buffer_load_dwordx4 v[240:243], v1, s[44:47], s4 offen offset:0 sc1
    buffer_load_dwordx4 v[244:247], v1, s[44:47], s4 offen offset:1024 sc1
    buffer_load_dwordx4 v[248:251], v1, s[44:47], s4 offen offset:2048 sc1
    buffer_load_dwordx4 v[252:255], v1, s[44:47], s4 offen offset:3072 sc1
    v_mfma_f32_16x16x16_bf16 v[28:31], v[10:11], v[10:11], 0
    s_waitcnt vmcnt(16)
    s_nop 4
    v_smfmac_f32_16x16x64_bf16 v[28:31], v[32:35], v[128:135], v2
    v_smfmac_f32_16x16x64_bf16 v[28:31], v[36:39], v[136:143], v2
    v_smfmac_f32_16x16x64_bf16 v[28:31], v[40:43], v[144:151], v2
    v_smfmac_f32_16x16x64_bf16 v[28:31], v[44:47], v[152:159], v2
    v_smfmac_f32_16x16x64_bf16 v[28:31], v[48:51], v[160:167], v2
    v_smfmac_f32_16x16x64_bf16 v[28:31], v[52:55], v[168:175], v2
    v_smfmac_f32_16x16x64_bf16 v[28:31], v[56:59], v[176:183], v2
    v_smfmac_f32_16x16x64_bf16 v[28:31], v[60:63], v[184:191], v2
    s_nop 7
    v_add_f32 v28, v28, v29
    v_add_f32 v30, v30, v31
    v_cvt_pk_bf16_f32 v28, v28, v30
    ds_write_b16 v5, v28 offset:2080
    ds_write_b16_d16_hi v5, v28 offset:2096
    s_mov_b64 exec, 1
    ds_add_u32 v10, v9 offset:3104
    s_mov_b64 exec, -1
    s_add_u32 s4, s8, 0x30000
    buffer_load_dwordx4 v[128:131], v1, s[44:47], s4 offen offset:0 sc1
    buffer_load_dwordx4 v[132:135], v1, s[44:47], s4 offen offset:1024 sc1
    buffer_load_dwordx4 v[136:139], v1, s[44:47], s4 offen offset:2048 sc1
    buffer_load_dwordx4 v[140:143], v1, s[44:47], s4 offen offset:3072 sc1
    s_add_u32 s4, s4, 4096
    buffer_load_dwordx4 v[144:147], v1, s[44:47], s4 offen offset:0 sc1
    buffer_load_dwordx4 v[148:151], v1, s[44:47], s4 offen offset:1024 sc1
    buffer_load_dwordx4 v[152:155], v1, s[44:47], s4 offen offset:2048 sc1
    buffer_load_dwordx4 v[156:159], v1, s[44:47], s4 offen offset:3072 sc1
    s_add_u32 s4, s4, 4096
    buffer_load_dwordx4 v[160:163], v1, s[44:47], s4 offen offset:0 sc1
    buffer_load_dwordx4 v[164:167], v1, s[44:47], s4 offen offset:1024 sc1
    buffer_load_dwordx4 v[168:171], v1, s[44:47], s4 offen offset:2048 sc1
    buffer_load_dwordx4 v[172:175], v1, s[44:47], s4 offen offset:3072 sc1
    s_add_u32 s4, s4, 4096
    buffer_load_dwordx4 v[176:179], v1, s[44:47], s4 offen offset:0 sc1
    buffer_load_dwordx4 v[180:183], v1, s[44:47], s4 offen offset:1024 sc1
    buffer_load_dwordx4 v[184:187], v1, s[44:47], s4 offen offset:2048 sc1
    buffer_load_dwordx4 v[188:191], v1, s[44:47], s4 offen offset:3072 sc1
    s_branch L_npoll_120x
L_npoll_120:
    s_sub_u32 s14, s14, 1
    s_cbranch_scc1 L_end_1
    s_sleep 8
L_npoll_120x:
    ds_read_b32 v24, v7 offset:0
    s_waitcnt lgkmcnt(0)
    v_cmp_eq_f32 vcc, -1.0, v24
    s_cbranch_vccnz L_npoll_120
    ds_read2st64_b32 v[16:17], v6 offset0:0 offset1:1
    ds_read2st64_b32 v[18:19], v6 offset0:9 offset1:10
    ds_read2st64_b32 v[20:21], v6 offset0:18 offset1:19
    ds_read2st64_b32 v[22:23], v6 offset0:27 offset1:28
    ds_write_b32 v7, v96 offset:0
    v_add_f32_dpp v24, v24, v24 quad_perm:[1,0,3,2] row_mask:0xf bank_mask:0xf
    s_nop 1
    v_add_f32_dpp v24, v24, v24 quad_perm:[2,3,0,1] row_mask:0xf bank_mask:0xf
    s_nop 0
    v_rcp_f32 v25, v24
    s_waitcnt lgkmcnt(3)
    v_add_f32 v16, v16, v18
    v_add_f32 v17, v17, v19
    s_waitcnt lgkmcnt(1)
    v_add_f32 v20, v20, v22
    v_add_f32 v21, v21, v23
    v_add_f32 v16, v16, v20
    v_add_f32 v17, v17, v21
    v_maximum3_f32 v12, |v16|, |v17|, v12
    v_mul_f32 v16, v16, v25
    v_mul_f32 v17, v17, v25
    v_maximum3_f32 v13, v24, v25, v13
    v_cvt_pk_bf16_f32 v16, v16, v17
    ds_write_b32 v8, v16 offset:0
    s_mov_b64 exec, 1
    ds_add_u32 v10, v9 offset:10496
    s_mov_b64 exec, -1
L_opoll_121:
    s_sub_u32 s14, s14, 1
    s_cbranch_scc1 L_end_1
    ds_read_b32 v16, v10 offset:10496
    ds_read_b128 v[28:31], v4 offset:0
    s_waitcnt lgkmcnt(0)
    v_cmp_ne_u32 vcc, 4, v16
    s_cbranch_vccnz L_opoll_121
    s_waitcnt vmcnt(16)
    v_smfmac_f32_16x16x64_bf16 v[64:67], v[28:31], v[192:199], v2
    s_add_u32 s4, s8, 0x90000
    buffer_load_dwordx4 v[192:195], v1, s[44:47], s4 offen offset:0 sc1
    buffer_load_dwordx4 v[196:199], v1, s[44:47], s4 offen offset:1024 sc1
    v_smfmac_f32_16x16x64_bf16 v[68:71], v[28:31], v[200:207], v2
    buffer_load_dwordx4 v[200:203], v1, s[44:47], s4 offen offset:2048 sc1
    buffer_load_dwordx4 v[204:207], v1, s[44:47], s4 offen offset:3072 sc1
    s_add_u32 s4, s4, 4096
    v_smfmac_f32_16x16x64_bf16 v[72:75], v[28:31], v[208:215], v2
    buffer_load_dwordx4 v[208:211], v1, s[44:47], s4 offen offset:0 sc1
    buffer_load_dwordx4 v[212:215], v1, s[44:47], s4 offen offset:1024 sc1
    v_smfmac_f32_16x16x64_bf16 v[76:79], v[28:31], v[216:223], v2
    buffer_load_dwordx4 v[216:219], v1, s[44:47], s4 offen offset:2048 sc1
    buffer_load_dwordx4 v[220:223], v1, s[44:47], s4 offen offset:3072 sc1
    s_add_u32 s4, s4, 4096
    v_smfmac_f32_16x16x64_bf16 v[80:83], v[28:31], v[224:231], v2
    buffer_load_dwordx4 v[224:227], v1, s[44:47], s4 offen offset:0 sc1
    buffer_load_dwordx4 v[228:231], v1, s[44:47], s4 offen offset:1024 sc1
    v_smfmac_f32_16x16x64_bf16 v[84:87], v[28:31], v[232:239], v2
    buffer_load_dwordx4 v[232:235], v1, s[44:47], s4 offen offset:2048 sc1
    buffer_load_dwordx4 v[236:239], v1, s[44:47], s4 offen offset:3072 sc1
    s_add_u32 s4, s4, 4096
    v_smfmac_f32_16x16x64_bf16 v[88:91], v[28:31], v[240:247], v2
    buffer_load_dwordx4 v[240:243], v1, s[44:47], s4 offen offset:0 sc1
    buffer_load_dwordx4 v[244:247], v1, s[44:47], s4 offen offset:1024 sc1
    v_smfmac_f32_16x16x64_bf16 v[92:95], v[28:31], v[248:255], v2
    buffer_load_dwordx4 v[248:251], v1, s[44:47], s4 offen offset:2048 sc1
    buffer_load_dwordx4 v[252:255], v1, s[44:47], s4 offen offset:3072 sc1
    s_cmp_lg_u32 s15, 0
    s_cbranch_scc1 L_hl2_114
    s_cmp_lt_u32 s3, 6
    s_cbranch_scc1 L_hl2_114x
    s_and_b32 s4, s2, 7
    s_lshr_b32 s5, s2, 3
    v_lshrrev_b32 v18, 2, v0
    v_mul_u32_u24 v18, 3584, v18
    v_and_b32 v19, 3, v0
    v_lshl_add_u32 v18, v19, 7, v18
    s_mul_i32 s10, s4, 448
    s_and_b32 s10, s10, 0xffffff80
    s_mul_i32 s11, s5, 57344
    s_add_u32 s10, s10, s11
    buffer_load_dword v97, v18, s[56:59], s10 offen
    v_lshlrev_b32 v19, 10, v0
    s_lshl_b32 s10, s5, 1
    s_and_b32 s11, s3, 1
    s_add_u32 s10, s10, s11
    s_mul_i32 s10, s10, 28672
    s_lshl_b32 s11, s4, 7
    s_add_u32 s10, s10, s11
    s_mov_b64 exec, 0xfffffff
    buffer_load_dword v98, v19, s[48:51], s10 offen
    s_mov_b64 exec, -1
    s_branch L_hl2_114
L_hl2_114x:
    v_mov_b32 v100, -1
    v_mov_b32 v101, -1
    v_mov_b32 v102, -1
    v_mov_b32 v103, -1
    s_lshl_b32 s4, s2, 10
    s_lshl_b32 s5, s9, 19
    s_add_u32 s4, s4, s5
    s_add_u32 s4, s4, 0x140000
    s_add_u32 s5, s4, 0x40000
    buffer_store_dwordx4 v[100:103], v1, s[44:47], s4 offen sc1
    buffer_store_dwordx4 v[100:103], v1, s[44:47], s5 offen sc1
    s_mov_b32 m0, 161792
    s_nop 0
    buffer_load_dwordx4 v1, s[60:63], 0 offen lds
L_hl2_114:
    v_mfma_f32_16x16x16_bf16 v[28:31], v[10:11], v[10:11], 0
    s_waitcnt vmcnt(16)
    s_nop 4
    v_smfmac_f32_16x16x64_bf16 v[28:31], v[32:35], v[128:135], v2
    v_smfmac_f32_16x16x64_bf16 v[28:31], v[36:39], v[136:143], v2
    v_smfmac_f32_16x16x64_bf16 v[28:31], v[40:43], v[144:151], v2
    v_smfmac_f32_16x16x64_bf16 v[28:31], v[44:47], v[152:159], v2
    v_smfmac_f32_16x16x64_bf16 v[28:31], v[48:51], v[160:167], v2
    v_smfmac_f32_16x16x64_bf16 v[28:31], v[52:55], v[168:175], v2
    v_smfmac_f32_16x16x64_bf16 v[28:31], v[56:59], v[176:183], v2
    v_smfmac_f32_16x16x64_bf16 v[28:31], v[60:63], v[184:191], v2
    s_nop 7
    v_add_f32 v28, v28, v29
    v_add_f32 v30, v30, v31
    v_cvt_pk_bf16_f32 v28, v28, v30
    ds_write_b16 v5, v28 offset:3120
    ds_write_b16_d16_hi v5, v28 offset:3136
    s_mov_b64 exec, 1
    ds_add_u32 v10, v9 offset:4144
    s_mov_b64 exec, -1
    s_add_u32 s4, s8, 0x40000
    buffer_load_dwordx4 v[128:131], v1, s[44:47], s4 offen offset:0 sc1
    buffer_load_dwordx4 v[132:135], v1, s[44:47], s4 offen offset:1024 sc1
    buffer_load_dwordx4 v[136:139], v1, s[44:47], s4 offen offset:2048 sc1
    buffer_load_dwordx4 v[140:143], v1, s[44:47], s4 offen offset:3072 sc1
    s_add_u32 s4, s4, 4096
    buffer_load_dwordx4 v[144:147], v1, s[44:47], s4 offen offset:0 sc1
    buffer_load_dwordx4 v[148:151], v1, s[44:47], s4 offen offset:1024 sc1
    buffer_load_dwordx4 v[152:155], v1, s[44:47], s4 offen offset:2048 sc1
    buffer_load_dwordx4 v[156:159], v1, s[44:47], s4 offen offset:3072 sc1
    s_add_u32 s4, s4, 4096
    buffer_load_dwordx4 v[160:163], v1, s[44:47], s4 offen offset:0 sc1
    buffer_load_dwordx4 v[164:167], v1, s[44:47], s4 offen offset:1024 sc1
    buffer_load_dwordx4 v[168:171], v1, s[44:47], s4 offen offset:2048 sc1
    buffer_load_dwordx4 v[172:175], v1, s[44:47], s4 offen offset:3072 sc1
    s_add_u32 s4, s4, 4096
    buffer_load_dwordx4 v[176:179], v1, s[44:47], s4 offen offset:0 sc1
    buffer_load_dwordx4 v[180:183], v1, s[44:47], s4 offen offset:1024 sc1
    buffer_load_dwordx4 v[184:187], v1, s[44:47], s4 offen offset:2048 sc1
    buffer_load_dwordx4 v[188:191], v1, s[44:47], s4 offen offset:3072 sc1
    s_branch L_npoll_122x
L_npoll_122:
    s_sub_u32 s14, s14, 1
    s_cbranch_scc1 L_end_1
    s_sleep 8
L_npoll_122x:
    ds_read_b32 v24, v7 offset:9216
    s_waitcnt lgkmcnt(0)
    v_cmp_eq_f32 vcc, -1.0, v24
    s_cbranch_vccnz L_npoll_122
    ds_read2st64_b32 v[16:17], v6 offset0:36 offset1:37
    ds_read2st64_b32 v[18:19], v6 offset0:45 offset1:46
    ds_read2st64_b32 v[20:21], v6 offset0:54 offset1:55
    ds_read2st64_b32 v[22:23], v6 offset0:63 offset1:64
    ds_write_b32 v7, v96 offset:9216
    v_add_f32_dpp v24, v24, v24 quad_perm:[1,0,3,2] row_mask:0xf bank_mask:0xf
    s_nop 1
    v_add_f32_dpp v24, v24, v24 quad_perm:[2,3,0,1] row_mask:0xf bank_mask:0xf
    s_nop 0
    v_rcp_f32 v25, v24
    s_waitcnt lgkmcnt(3)
    v_add_f32 v16, v16, v18
    v_add_f32 v17, v17, v19
    s_waitcnt lgkmcnt(1)
    v_add_f32 v20, v20, v22
    v_add_f32 v21, v21, v23
    v_add_f32 v16, v16, v20
    v_add_f32 v17, v17, v21
    v_maximum3_f32 v12, |v16|, |v17|, v12
    v_mul_f32 v16, v16, v25
    v_mul_f32 v17, v17, v25
    v_maximum3_f32 v13, v24, v25, v13
    v_cvt_pk_bf16_f32 v16, v16, v17
    ds_write_b32 v8, v16 offset:128
    s_mov_b64 exec, 1
    ds_add_u32 v10, v9 offset:10500
    s_mov_b64 exec, -1
L_opoll_123:
    s_sub_u32 s14, s14, 1
    s_cbranch_scc1 L_end_1
    ds_read_b32 v16, v10 offset:10500
    ds_read_b128 v[28:31], v4 offset:128
    s_waitcnt lgkmcnt(0)
    v_cmp_ne_u32 vcc, 4, v16
    s_cbranch_vccnz L_opoll_123
    s_waitcnt vmcnt(16)
    v_smfmac_f32_16x16x64_bf16 v[64:67], v[28:31], v[192:199], v2
    s_add_u32 s4, s8, 0xa0000
    buffer_load_dwordx4 v[192:195], v1, s[44:47], s4 offen offset:0 sc1
    buffer_load_dwordx4 v[196:199], v1, s[44:47], s4 offen offset:1024 sc1
    v_smfmac_f32_16x16x64_bf16 v[68:71], v[28:31], v[200:207], v2
    buffer_load_dwordx4 v[200:203], v1, s[44:47], s4 offen offset:2048 sc1
    buffer_load_dwordx4 v[204:207], v1, s[44:47], s4 offen offset:3072 sc1
    s_add_u32 s4, s4, 4096
    v_smfmac_f32_16x16x64_bf16 v[72:75], v[28:31], v[208:215], v2
    buffer_load_dwordx4 v[208:211], v1, s[44:47], s4 offen offset:0 sc1
    buffer_load_dwordx4 v[212:215], v1, s[44:47], s4 offen offset:1024 sc1
    v_smfmac_f32_16x16x64_bf16 v[76:79], v[28:31], v[216:223], v2
    buffer_load_dwordx4 v[216:219], v1, s[44:47], s4 offen offset:2048 sc1
    buffer_load_dwordx4 v[220:223], v1, s[44:47], s4 offen offset:3072 sc1
    s_add_u32 s4, s4, 4096
    v_smfmac_f32_16x16x64_bf16 v[80:83], v[28:31], v[224:231], v2
    buffer_load_dwordx4 v[224:227], v1, s[44:47], s4 offen offset:0 sc1
    buffer_load_dwordx4 v[228:231], v1, s[44:47], s4 offen offset:1024 sc1
    v_smfmac_f32_16x16x64_bf16 v[84:87], v[28:31], v[232:239], v2
    buffer_load_dwordx4 v[232:235], v1, s[44:47], s4 offen offset:2048 sc1
    buffer_load_dwordx4 v[236:239], v1, s[44:47], s4 offen offset:3072 sc1
    s_add_u32 s4, s4, 4096
    v_smfmac_f32_16x16x64_bf16 v[88:91], v[28:31], v[240:247], v2
    buffer_load_dwordx4 v[240:243], v1, s[44:47], s4 offen offset:0 sc1
    buffer_load_dwordx4 v[244:247], v1, s[44:47], s4 offen offset:1024 sc1
    v_smfmac_f32_16x16x64_bf16 v[92:95], v[28:31], v[248:255], v2
    buffer_load_dwordx4 v[248:251], v1, s[44:47], s4 offen offset:2048 sc1
    buffer_load_dwordx4 v[252:255], v1, s[44:47], s4 offen offset:3072 sc1
    v_mfma_f32_16x16x16_bf16 v[28:31], v[10:11], v[10:11], 0
    s_waitcnt vmcnt(16)
    s_nop 4
    v_smfmac_f32_16x16x64_bf16 v[28:31], v[32:35], v[128:135], v2
    v_smfmac_f32_16x16x64_bf16 v[28:31], v[36:39], v[136:143], v2
    v_smfmac_f32_16x16x64_bf16 v[28:31], v[40:43], v[144:151], v2
    v_smfmac_f32_16x16x64_bf16 v[28:31], v[44:47], v[152:159], v2
    v_smfmac_f32_16x16x64_bf16 v[28:31], v[48:51], v[160:167], v2
    v_smfmac_f32_16x16x64_bf16 v[28:31], v[52:55], v[168:175], v2
    v_smfmac_f32_16x16x64_bf16 v[28:31], v[56:59], v[176:183], v2
    v_smfmac_f32_16x16x64_bf16 v[28:31], v[60:63], v[184:191], v2
    s_nop 7
    v_add_f32 v28, v28, v29
    v_add_f32 v30, v30, v31
    v_cvt_pk_bf16_f32 v28, v28, v30
    ds_write_b16 v5, v28 offset:4160
    ds_write_b16_d16_hi v5, v28 offset:4176
    s_mov_b64 exec, 1
    ds_add_u32 v10, v9 offset:5184
    s_mov_b64 exec, -1
    s_add_u32 s4, s8, 0x50000
    buffer_load_dwordx4 v[128:131], v1, s[44:47], s4 offen offset:0 sc1
    buffer_load_dwordx4 v[132:135], v1, s[44:47], s4 offen offset:1024 sc1
    buffer_load_dwordx4 v[136:139], v1, s[44:47], s4 offen offset:2048 sc1
    buffer_load_dwordx4 v[140:143], v1, s[44:47], s4 offen offset:3072 sc1
    s_add_u32 s4, s4, 4096
    buffer_load_dwordx4 v[144:147], v1, s[44:47], s4 offen offset:0 sc1
    buffer_load_dwordx4 v[148:151], v1, s[44:47], s4 offen offset:1024 sc1
    buffer_load_dwordx4 v[152:155], v1, s[44:47], s4 offen offset:2048 sc1
    buffer_load_dwordx4 v[156:159], v1, s[44:47], s4 offen offset:3072 sc1
    s_add_u32 s4, s4, 4096
    buffer_load_dwordx4 v[160:163], v1, s[44:47], s4 offen offset:0 sc1
    buffer_load_dwordx4 v[164:167], v1, s[44:47], s4 offen offset:1024 sc1
    buffer_load_dwordx4 v[168:171], v1, s[44:47], s4 offen offset:2048 sc1
    buffer_load_dwordx4 v[172:175], v1, s[44:47], s4 offen offset:3072 sc1
    s_add_u32 s4, s4, 4096
    buffer_load_dwordx4 v[176:179], v1, s[44:47], s4 offen offset:0 sc1
    buffer_load_dwordx4 v[180:183], v1, s[44:47], s4 offen offset:1024 sc1
    buffer_load_dwordx4 v[184:187], v1, s[44:47], s4 offen offset:2048 sc1
    buffer_load_dwordx4 v[188:191], v1, s[44:47], s4 offen offset:3072 sc1
    s_branch L_npoll_124x
L_npoll_124:
    s_sub_u32 s14, s14, 1
    s_cbranch_scc1 L_end_1
    s_sleep 8
L_npoll_124x:
    ds_read_b32 v24, v7 offset:0
    s_waitcnt lgkmcnt(0)
    v_cmp_eq_f32 vcc, -1.0, v24
    s_cbranch_vccnz L_npoll_124
    ds_read2st64_b32 v[16:17], v6 offset0:0 offset1:1
    ds_read2st64_b32 v[18:19], v6 offset0:9 offset1:10
    ds_read2st64_b32 v[20:21], v6 offset0:18 offset1:19
    ds_read2st64_b32 v[22:23], v6 offset0:27 offset1:28
    ds_write_b32 v7, v96 offset:0
    v_add_f32_dpp v24, v24, v24 quad_perm:[1,0,3,2] row_mask:0xf bank_mask:0xf
    s_nop 1
    v_add_f32_dpp v24, v24, v24 quad_perm:[2,3,0,1] row_mask:0xf bank_mask:0xf
    s_nop 0
    v_rcp_f32 v25, v24
    s_waitcnt lgkmcnt(3)
    v_add_f32 v16, v16, v18
    v_add_f32 v17, v17, v19
    s_waitcnt lgkmcnt(1)
    v_add_f32 v20, v20, v22
    v_add_f32 v21, v21, v23
    v_add_f32 v16, v16, v20
    v_add_f32 v17, v17, v21
    v_maximum3_f32 v12, |v16|, |v17|, v12
    v_mul_f32 v16, v16, v25
    v_mul_f32 v17, v17, v25
    v_maximum3_f32 v13, v24, v25, v13
    v_cvt_pk_bf16_f32 v16, v16, v17
    ds_write_b32 v8, v16 offset:256
    s_mov_b64 exec, 1
    ds_add_u32 v10, v9 offset:10504
    s_mov_b64 exec, -1
L_opoll_125:
    s_sub_u32 s14, s14, 1
    s_cbranch_scc1 L_end_1
    ds_read_b32 v16, v10 offset:10504
    ds_read_b128 v[28:31], v4 offset:256
    s_waitcnt lgkmcnt(0)
    v_cmp_ne_u32 vcc, 4, v16
    s_cbranch_vccnz L_opoll_125
    s_waitcnt vmcnt(16)
    v_smfmac_f32_16x16x64_bf16 v[64:67], v[28:31], v[192:199], v2
    s_add_u32 s4, s8, 0xb0000
    buffer_load_dwordx4 v[192:195], v1, s[44:47], s4 offen offset:0 sc1
    buffer_load_dwordx4 v[196:199], v1, s[44:47], s4 offen offset:1024 sc1
    v_smfmac_f32_16x16x64_bf16 v[68:71], v[28:31], v[200:207], v2
    buffer_load_dwordx4 v[200:203], v1, s[44:47], s4 offen offset:2048 sc1
    buffer_load_dwordx4 v[204:207], v1, s[44:47], s4 offen offset:3072 sc1
    s_add_u32 s4, s4, 4096
    v_smfmac_f32_16x16x64_bf16 v[72:75], v[28:31], v[208:215], v2
    buffer_load_dwordx4 v[208:211], v1, s[44:47], s4 offen offset:0 sc1
    buffer_load_dwordx4 v[212:215], v1, s[44:47], s4 offen offset:1024 sc1
    v_smfmac_f32_16x16x64_bf16 v[76:79], v[28:31], v[216:223], v2
    buffer_load_dwordx4 v[216:219], v1, s[44:47], s4 offen offset:2048 sc1
    buffer_load_dwordx4 v[220:223], v1, s[44:47], s4 offen offset:3072 sc1
    s_add_u32 s4, s4, 4096
    v_smfmac_f32_16x16x64_bf16 v[80:83], v[28:31], v[224:231], v2
    buffer_load_dwordx4 v[224:227], v1, s[44:47], s4 offen offset:0 sc1
    buffer_load_dwordx4 v[228:231], v1, s[44:47], s4 offen offset:1024 sc1
    v_smfmac_f32_16x16x64_bf16 v[84:87], v[28:31], v[232:239], v2
    buffer_load_dwordx4 v[232:235], v1, s[44:47], s4 offen offset:2048 sc1
    buffer_load_dwordx4 v[236:239], v1, s[44:47], s4 offen offset:3072 sc1
    s_add_u32 s4, s4, 4096
    v_smfmac_f32_16x16x64_bf16 v[88:91], v[28:31], v[240:247], v2
    buffer_load_dwordx4 v[240:243], v1, s[44:47], s4 offen offset:0 sc1
    buffer_load_dwordx4 v[244:247], v1, s[44:47], s4 offen offset:1024 sc1
    v_smfmac_f32_16x16x64_bf16 v[92:95], v[28:31], v[248:255], v2
    buffer_load_dwordx4 v[248:251], v1, s[44:47], s4 offen offset:2048 sc1
    buffer_load_dwordx4 v[252:255], v1, s[44:47], s4 offen offset:3072 sc1
    s_cmp_lg_u32 s15, 0
    s_cbranch_scc1 L_stage_126
    s_cmp_eq_u32 s96, 0
    s_cbranch_scc1 L_stage_126
    s_mov_b32 m0, s100
    s_add_u32 s100, s100, 1024
    buffer_load_dwordx4 v15, s[64:67], s98 offen lds
    s_add_u32 s98, s98, s99
    s_mov_b32 m0, s100
    s_add_u32 s100, s100, 1024
    buffer_load_dwordx4 v15, s[64:67], s98 offen lds
    s_add_u32 s98, s98, s99
L_stage_126:
    v_mfma_f32_16x16x16_bf16 v[28:31], v[10:11], v[10:11], 0
    s_waitcnt vmcnt(16)
    s_nop 4
    v_smfmac_f32_16x16x64_bf16 v[28:31], v[32:35], v[128:135], v2
    v_smfmac_f32_16x16x64_bf16 v[28:31], v[36:39], v[136:143], v2
    v_smfmac_f32_16x16x64_bf16 v[28:31], v[40:43], v[144:151], v2
    v_smfmac_f32_16x16x64_bf16 v[28:31], v[44:47], v[152:159], v2
    v_smfmac_f32_16x16x64_bf16 v[28:31], v[48:51], v[160:167], v2
    v_smfmac_f32_16x16x64_bf16 v[28:31], v[52:55], v[168:175], v2
    v_smfmac_f32_16x16x64_bf16 v[28:31], v[56:59], v[176:183], v2
    v_smfmac_f32_16x16x64_bf16 v[28:31], v[60:63], v[184:191], v2
    s_nop 7
    v_add_f32 v28, v28, v29
    v_add_f32 v30, v30, v31
    v_cvt_pk_bf16_f32 v28, v28, v30
    ds_write_b16 v5, v28 offset:5200
    ds_write_b16_d16_hi v5, v28 offset:5216
    s_mov_b64 exec, 1
    ds_add_u32 v10, v9 offset:6224
    s_mov_b64 exec, -1
    s_add_u32 s4, s8, 0x60000
    buffer_load_dwordx4 v[128:131], v1, s[44:47], s4 offen offset:0 sc1
    buffer_load_dwordx4 v[132:135], v1, s[44:47], s4 offen offset:1024 sc1
    buffer_load_dwordx4 v[136:139], v1, s[44:47], s4 offen offset:2048 sc1
    buffer_load_dwordx4 v[140:143], v1, s[44:47], s4 offen offset:3072 sc1
    s_add_u32 s4, s4, 4096
    buffer_load_dwordx4 v[144:147], v1, s[44:47], s4 offen offset:0 sc1
    buffer_load_dwordx4 v[148:151], v1, s[44:47], s4 offen offset:1024 sc1
    buffer_load_dwordx4 v[152:155], v1, s[44:47], s4 offen offset:2048 sc1
    buffer_load_dwordx4 v[156:159], v1, s[44:47], s4 offen offset:3072 sc1
    s_add_u32 s4, s4, 4096
    buffer_load_dwordx4 v[160:163], v1, s[44:47], s4 offen offset:0 sc1
    buffer_load_dwordx4 v[164:167], v1, s[44:47], s4 offen offset:1024 sc1
    buffer_load_dwordx4 v[168:171], v1, s[44:47], s4 offen offset:2048 sc1
    buffer_load_dwordx4 v[172:175], v1, s[44:47], s4 offen offset:3072 sc1
    s_add_u32 s4, s4, 4096
    buffer_load_dwordx4 v[176:179], v1, s[44:47], s4 offen offset:0 sc1
    buffer_load_dwordx4 v[180:183], v1, s[44:47], s4 offen offset:1024 sc1
    buffer_load_dwordx4 v[184:187], v1, s[44:47], s4 offen offset:2048 sc1
    buffer_load_dwordx4 v[188:191], v1, s[44:47], s4 offen offset:3072 sc1
    s_branch L_npoll_127x
L_npoll_127:
    s_sub_u32 s14, s14, 1
    s_cbranch_scc1 L_end_1
    s_sleep 8
L_npoll_127x:
    ds_read_b32 v24, v7 offset:9216
    s_waitcnt lgkmcnt(0)
    v_cmp_eq_f32 vcc, -1.0, v24
    s_cbranch_vccnz L_npoll_127
    ds_read2st64_b32 v[16:17], v6 offset0:36 offset1:37
    ds_read2st64_b32 v[18:19], v6 offset0:45 offset1:46
    ds_read2st64_b32 v[20:21], v6 offset0:54 offset1:55
    ds_read2st64_b32 v[22:23], v6 offset0:63 offset1:64
    ds_write_b32 v7, v96 offset:9216
    v_add_f32_dpp v24, v24, v24 quad_perm:[1,0,3,2] row_mask:0xf bank_mask:0xf
    s_nop 1
    v_add_f32_dpp v24, v24, v24 quad_perm:[2,3,0,1] row_mask:0xf bank_mask:0xf
    s_nop 0
    v_rcp_f32 v25, v24
    s_waitcnt lgkmcnt(3)
    v_add_f32 v16, v16, v18
    v_add_f32 v17, v17, v19
    s_waitcnt lgkmcnt(1)
    v_add_f32 v20, v20, v22
    v_add_f32 v21, v21, v23
    v_add_f32 v16, v16, v20
    v_add_f32 v17, v17, v21
    v_maximum3_f32 v12, |v16|, |v17|, v12
    v_mul_f32 v16, v16, v25
    v_mul_f32 v17, v17, v25
    v_maximum3_f32 v13, v24, v25, v13
    v_cvt_pk_bf16_f32 v16, v16, v17
    ds_write_b32 v8, v16 offset:384
    s_mov_b64 exec, 1
    ds_add_u32 v10, v9 offset:10508
    s_mov_b64 exec, -1
L_opoll_128:
    s_sub_u32 s14, s14, 1
    s_cbranch_scc1 L_end_1
    ds_read_b32 v16, v10 offset:10508
    ds_read_b128 v[28:31], v4 offset:384
    s_waitcnt lgkmcnt(0)
    v_cmp_ne_u32 vcc, 4, v16
    s_cbranch_vccnz L_opoll_128
    s_waitcnt vmcnt(16)
    v_smfmac_f32_16x16x64_bf16 v[64:67], v[28:31], v[192:199], v2
    s_add_u32 s4, s8, 0xc0000
    buffer_load_dwordx4 v[192:195], v1, s[44:47], s4 offen offset:0 sc1
    buffer_load_dwordx4 v[196:199], v1, s[44:47], s4 offen offset:1024 sc1
    v_smfmac_f32_16x16x64_bf16 v[68:71], v[28:31], v[200:207], v2
    buffer_load_dwordx4 v[200:203], v1, s[44:47], s4 offen offset:2048 sc1
    buffer_load_dwordx4 v[204:207], v1, s[44:47], s4 offen offset:3072 sc1
    s_add_u32 s4, s4, 4096
    v_smfmac_f32_16x16x64_bf16 v[72:75], v[28:31], v[208:215], v2
    buffer_load_dwordx4 v[208:211], v1, s[44:47], s4 offen offset:0 sc1
    buffer_load_dwordx4 v[212:215], v1, s[44:47], s4 offen offset:1024 sc1
    v_smfmac_f32_16x16x64_bf16 v[76:79], v[28:31], v[216:223], v2
    buffer_load_dwordx4 v[216:219], v1, s[44:47], s4 offen offset:2048 sc1
    buffer_load_dwordx4 v[220:223], v1, s[44:47], s4 offen offset:3072 sc1
    s_add_u32 s4, s4, 4096
    v_smfmac_f32_16x16x64_bf16 v[80:83], v[28:31], v[224:231], v2
    buffer_load_dwordx4 v[224:227], v1, s[44:47], s4 offen offset:0 sc1
    buffer_load_dwordx4 v[228:231], v1, s[44:47], s4 offen offset:1024 sc1
    v_smfmac_f32_16x16x64_bf16 v[84:87], v[28:31], v[232:239], v2
    buffer_load_dwordx4 v[232:235], v1, s[44:47], s4 offen offset:2048 sc1
    buffer_load_dwordx4 v[236:239], v1, s[44:47], s4 offen offset:3072 sc1
    s_add_u32 s4, s4, 4096
    v_smfmac_f32_16x16x64_bf16 v[88:91], v[28:31], v[240:247], v2
    buffer_load_dwordx4 v[240:243], v1, s[44:47], s4 offen offset:0 sc1
    buffer_load_dwordx4 v[244:247], v1, s[44:47], s4 offen offset:1024 sc1
    v_smfmac_f32_16x16x64_bf16 v[92:95], v[28:31], v[248:255], v2
    buffer_load_dwordx4 v[248:251], v1, s[44:47], s4 offen offset:2048 sc1
    buffer_load_dwordx4 v[252:255], v1, s[44:47], s4 offen offset:3072 sc1
    s_cmp_lg_u32 s15, 0
    s_cbranch_scc1 L_stage_129
    s_mov_b32 m0, s100
    s_add_u32 s100, s100, 1024
    buffer_load_dwordx4 v15, s[64:67], s98 offen lds
    s_add_u32 s98, s98, s99
    s_cmp_eq_u32 s96, 0
    s_cbranch_scc1 L_stage_129
    s_mov_b32 m0, s100
    s_add_u32 s100, s100, 1024
    buffer_load_dwordx4 v15, s[64:67], s98 offen lds
    s_add_u32 s98, s98, s99
L_stage_129:
    v_mfma_f32_16x16x16_bf16 v[28:31], v[10:11], v[10:11], 0
    s_waitcnt vmcnt(16)
    s_nop 4
    v_smfmac_f32_16x16x64_bf16 v[28:31], v[32:35], v[128:135], v2
    v_smfmac_f32_16x16x64_bf16 v[28:31], v[36:39], v[136:143], v2
    v_smfmac_f32_16x16x64_bf16 v[28:31], v[40:43], v[144:151], v2
    v_smfmac_f32_16x16x64_bf16 v[28:31], v[44:47], v[152:159], v2
    v_smfmac_f32_16x16x64_bf16 v[28:31], v[48:51], v[160:167], v2
    v_smfmac_f32_16x16x64_bf16 v[28:31], v[52:55], v[168:175], v2
    v_smfmac_f32_16x16x64_bf16 v[28:31], v[56:59], v[176:183], v2
    v_smfmac_f32_16x16x64_bf16 v[28:31], v[60:63], v[184:191], v2
    s_nop 7
    v_add_f32 v28, v28, v29
    v_add_f32 v30, v30, v31
    v_cvt_pk_bf16_f32 v28, v28, v30
    ds_write_b16 v5, v28 offset:6240
    ds_write_b16_d16_hi v5, v28 offset:6256
    s_mov_b64 exec, 1
    ds_add_u32 v10, v9 offset:7264
    s_mov_b64 exec, -1
    s_add_u32 s4, s8, 0x70000
    buffer_load_dwordx4 v[128:131], v1, s[44:47], s4 offen offset:0 sc1
    buffer_load_dwordx4 v[132:135], v1, s[44:47], s4 offen offset:1024 sc1
    buffer_load_dwordx4 v[136:139], v1, s[44:47], s4 offen offset:2048 sc1
    buffer_load_dwordx4 v[140:143], v1, s[44:47], s4 offen offset:3072 sc1
    s_add_u32 s4, s4, 4096
    buffer_load_dwordx4 v[144:147], v1, s[44:47], s4 offen offset:0 sc1
    buffer_load_dwordx4 v[148:151], v1, s[44:47], s4 offen offset:1024 sc1
    buffer_load_dwordx4 v[152:155], v1, s[44:47], s4 offen offset:2048 sc1
    buffer_load_dwordx4 v[156:159], v1, s[44:47], s4 offen offset:3072 sc1
    s_add_u32 s4, s4, 4096
    buffer_load_dwordx4 v[160:163], v1, s[44:47], s4 offen offset:0 sc1
    buffer_load_dwordx4 v[164:167], v1, s[44:47], s4 offen offset:1024 sc1
    buffer_load_dwordx4 v[168:171], v1, s[44:47], s4 offen offset:2048 sc1
    buffer_load_dwordx4 v[172:175], v1, s[44:47], s4 offen offset:3072 sc1
    s_add_u32 s4, s4, 4096
    buffer_load_dwordx4 v[176:179], v1, s[44:47], s4 offen offset:0 sc1
    buffer_load_dwordx4 v[180:183], v1, s[44:47], s4 offen offset:1024 sc1
    buffer_load_dwordx4 v[184:187], v1, s[44:47], s4 offen offset:2048 sc1
    buffer_load_dwordx4 v[188:191], v1, s[44:47], s4 offen offset:3072 sc1
    s_branch L_npoll_130x
L_npoll_130:
    s_sub_u32 s14, s14, 1
    s_cbranch_scc1 L_end_1
    s_sleep 8
L_npoll_130x:
    ds_read_b32 v24, v7 offset:0
    s_waitcnt lgkmcnt(0)
    v_cmp_eq_f32 vcc, -1.0, v24
    s_cbranch_vccnz L_npoll_130
    ds_read2st64_b32 v[16:17], v6 offset0:0 offset1:1
    ds_read2st64_b32 v[18:19], v6 offset0:9 offset1:10
    ds_read2st64_b32 v[20:21], v6 offset0:18 offset1:19
    ds_read2st64_b32 v[22:23], v6 offset0:27 offset1:28
    ds_write_b32 v7, v96 offset:0
    v_add_f32_dpp v24, v24, v24 quad_perm:[1,0,3,2] row_mask:0xf bank_mask:0xf
    s_nop 1
    v_add_f32_dpp v24, v24, v24 quad_perm:[2,3,0,1] row_mask:0xf bank_mask:0xf
    s_nop 0
    v_rcp_f32 v25, v24
    s_waitcnt lgkmcnt(3)
    v_add_f32 v16, v16, v18
    v_add_f32 v17, v17, v19
    s_waitcnt lgkmcnt(1)
    v_add_f32 v20, v20, v22
    v_add_f32 v21, v21, v23
    v_add_f32 v16, v16, v20
    v_add_f32 v17, v17, v21
    v_maximum3_f32 v12, |v16|, |v17|, v12
    v_mul_f32 v16, v16, v25
    v_mul_f32 v17, v17, v25
    v_maximum3_f32 v13, v24, v25, v13
    v_cvt_pk_bf16_f32 v16, v16, v17
    ds_write_b32 v8, v16 offset:512
    s_mov_b64 exec, 1
    ds_add_u32 v10, v9 offset:10512
    s_mov_b64 exec, -1
L_opoll_131:
    s_sub_u32 s14, s14, 1
    s_cbranch_scc1 L_end_1
    ds_read_b32 v16, v10 offset:10512
    ds_read_b128 v[28:31], v4 offset:512
    s_waitcnt lgkmcnt(0)
    v_cmp_ne_u32 vcc, 4, v16
    s_cbranch_vccnz L_opoll_131
    s_waitcnt vmcnt(16)
    v_smfmac_f32_16x16x64_bf16 v[64:67], v[28:31], v[192:199], v2
    s_add_u32 s4, s8, 0xd0000
    buffer_load_dwordx4 v[192:195], v1, s[44:47], s4 offen offset:0 sc1
    buffer_load_dwordx4 v[196:199], v1, s[44:47], s4 offen offset:1024 sc1
    v_smfmac_f32_16x16x64_bf16 v[68:71], v[28:31], v[200:207], v2
    buffer_load_dwordx4 v[200:203], v1, s[44:47], s4 offen offset:2048 sc1
    buffer_load_dwordx4 v[204:207], v1, s[44:47], s4 offen offset:3072 sc1
    s_add_u32 s4, s4, 4096
    v_smfmac_f32_16x16x64_bf16 v[72:75], v[28:31], v[208:215], v2
    buffer_load_dwordx4 v[208:211], v1, s[44:47], s4 offen offset:0 sc1
    buffer_load_dwordx4 v[212:215], v1, s[44:47], s4 offen offset:1024 sc1
    v_smfmac_f32_16x16x64_bf16 v[76:79], v[28:31], v[216:223], v2
    buffer_load_dwordx4 v[216:219], v1, s[44:47], s4 offen offset:2048 sc1
    buffer_load_dwordx4 v[220:223], v1, s[44:47], s4 offen offset:3072 sc1
    s_add_u32 s4, s4, 4096
    v_smfmac_f32_16x16x64_bf16 v[80:83], v[28:31], v[224:231], v2
    buffer_load_dwordx4 v[224:227], v1, s[44:47], s4 offen offset:0 sc1
    buffer_load_dwordx4 v[228:231], v1, s[44:47], s4 offen offset:1024 sc1
    v_smfmac_f32_16x16x64_bf16 v[84:87], v[28:31], v[232:239], v2
    buffer_load_dwordx4 v[232:235], v1, s[44:47], s4 offen offset:2048 sc1
    buffer_load_dwordx4 v[236:239], v1, s[44:47], s4 offen offset:3072 sc1
    s_add_u32 s4, s4, 4096
    v_smfmac_f32_16x16x64_bf16 v[88:91], v[28:31], v[240:247], v2
    buffer_load_dwordx4 v[240:243], v1, s[44:47], s4 offen offset:0 sc1
    buffer_load_dwordx4 v[244:247], v1, s[44:47], s4 offen offset:1024 sc1
    v_smfmac_f32_16x16x64_bf16 v[92:95], v[28:31], v[248:255], v2
    buffer_load_dwordx4 v[248:251], v1, s[44:47], s4 offen offset:2048 sc1
    buffer_load_dwordx4 v[252:255], v1, s[44:47], s4 offen offset:3072 sc1
    s_cmp_lg_u32 s15, 0
    s_cbranch_scc1 L_stage_132
    s_mov_b32 m0, s100
    s_add_u32 s100, s100, 1024
    buffer_load_dwordx4 v15, s[64:67], s98 offen lds
    s_add_u32 s98, s98, s99
    s_cmp_eq_u32 s96, 0
    s_cbranch_scc1 L_stage_132
    s_mov_b32 m0, s100
    s_add_u32 s100, s100, 1024
    buffer_load_dwordx4 v15, s[64:67], s98 offen lds
    s_add_u32 s98, s98, s99
L_stage_132:
    v_mfma_f32_16x16x16_bf16 v[28:31], v[10:11], v[10:11], 0
    s_waitcnt vmcnt(16)
    s_nop 4
    v_smfmac_f32_16x16x64_bf16 v[28:31], v[32:35], v[128:135], v2
    v_smfmac_f32_16x16x64_bf16 v[28:31], v[36:39], v[136:143], v2
    v_smfmac_f32_16x16x64_bf16 v[28:31], v[40:43], v[144:151], v2
    v_smfmac_f32_16x16x64_bf16 v[28:31], v[44:47], v[152:159], v2
    v_smfmac_f32_16x16x64_bf16 v[28:31], v[48:51], v[160:167], v2
    v_smfmac_f32_16x16x64_bf16 v[28:31], v[52:55], v[168:175], v2
    v_smfmac_f32_16x16x64_bf16 v[28:31], v[56:59], v[176:183], v2
    v_smfmac_f32_16x16x64_bf16 v[28:31], v[60:63], v[184:191], v2
    s_nop 7
    v_add_f32 v28, v28, v29
    v_add_f32 v30, v30, v31
    v_cvt_pk_bf16_f32 v28, v28, v30
    ds_write_b16 v5, v28 offset:7280
    ds_write_b16_d16_hi v5, v28 offset:7296
    s_mov_b64 exec, 1
    ds_add_u32 v10, v9 offset:8304
    s_mov_b64 exec, -1
    s_branch L_npoll_133x
L_npoll_133:
    s_sub_u32 s14, s14, 1
    s_cbranch_scc1 L_end_1
    s_sleep 8
L_npoll_133x:
    ds_read_b32 v24, v7 offset:9216
    s_waitcnt lgkmcnt(0)
    v_cmp_eq_f32 vcc, -1.0, v24
    s_cbranch_vccnz L_npoll_133
    ds_read2st64_b32 v[16:17], v6 offset0:36 offset1:37
    ds_read2st64_b32 v[18:19], v6 offset0:45 offset1:46
    ds_read2st64_b32 v[20:21], v6 offset0:54 offset1:55
    ds_read2st64_b32 v[22:23], v6 offset0:63 offset1:64
    ds_write_b32 v7, v96 offset:9216
    v_add_f32_dpp v24, v24, v24 quad_perm:[1,0,3,2] row_mask:0xf bank_mask:0xf
    s_nop 1
    v_add_f32_dpp v24, v24, v24 quad_perm:[2,3,0,1] row_mask:0xf bank_mask:0xf
    s_nop 0
    v_rcp_f32 v25, v24
    s_waitcnt lgkmcnt(3)
    v_add_f32 v16, v16, v18
    v_add_f32 v17, v17, v19
    s_waitcnt lgkmcnt(1)
    v_add_f32 v20, v20, v22
    v_add_f32 v21, v21, v23
    v_add_f32 v16, v16, v20
    v_add_f32 v17, v17, v21
    v_maximum3_f32 v12, |v16|, |v17|, v12
    v_mul_f32 v16, v16, v25
    v_mul_f32 v17, v17, v25
    v_maximum3_f32 v13, v24, v25, v13
    v_cvt_pk_bf16_f32 v16, v16, v17
    ds_write_b32 v8, v16 offset:640
    s_mov_b64 exec, 1
    ds_add_u32 v10, v9 offset:10516
    s_mov_b64 exec, -1
    s_mov_b64 exec, 1
    ds_add_u32 v10, v9 offset:9344
    s_mov_b64 exec, -1
L_opoll_134:
    s_sub_u32 s14, s14, 1
    s_cbranch_scc1 L_end_1
    ds_read_b32 v16, v10 offset:10516
    ds_read_b128 v[28:31], v4 offset:640
    s_waitcnt lgkmcnt(0)
    v_cmp_ne_u32 vcc, 4, v16
    s_cbranch_vccnz L_opoll_134
    s_waitcnt vmcnt(0)
    v_smfmac_f32_16x16x64_bf16 v[64:67], v[28:31], v[192:199], v2
    s_add_u32 s4, s8, 0xe0000
    buffer_load_dwordx4 v[192:195], v1, s[44:47], s4 offen offset:0 sc1
    buffer_load_dwordx4 v[196:199], v1, s[44:47], s4 offen offset:1024 sc1
    v_smfmac_f32_16x16x64_bf16 v[68:71], v[28:31], v[200:207], v2
    buffer_load_dwordx4 v[200:203], v1, s[44:47], s4 offen offset:2048 sc1
    buffer_load_dwordx4 v[204:207], v1, s[44:47], s4 offen offset:3072 sc1
    s_add_u32 s4, s4, 4096
    v_smfmac_f32_16x16x64_bf16 v[72:75], v[28:31], v[208:215], v2
    buffer_load_dwordx4 v[208:211], v1, s[44:47], s4 offen offset:0 sc1
    buffer_load_dwordx4 v[212:215], v1, s[44:47], s4 offen offset:1024 sc1
    v_smfmac_f32_16x16x64_bf16 v[76:79], v[28:31], v[216:223], v2
    buffer_load_dwordx4 v[216:219], v1, s[44:47], s4 offen offset:2048 sc1
    buffer_load_dwordx4 v[220:223], v1, s[44:47], s4 offen offset:3072 sc1
    s_add_u32 s4, s4, 4096
    v_smfmac_f32_16x16x64_bf16 v[80:83], v[28:31], v[224:231], v2
    buffer_load_dwordx4 v[224:227], v1, s[44:47], s4 offen offset:0 sc1
    buffer_load_dwordx4 v[228:231], v1, s[44:47], s4 offen offset:1024 sc1
    v_smfmac_f32_16x16x64_bf16 v[84:87], v[28:31], v[232:239], v2
    buffer_load_dwordx4 v[232:235], v1, s[44:47], s4 offen offset:2048 sc1
    buffer_load_dwordx4 v[236:239], v1, s[44:47], s4 offen offset:3072 sc1
    s_add_u32 s4, s4, 4096
    v_smfmac_f32_16x16x64_bf16 v[88:91], v[28:31], v[240:247], v2
    buffer_load_dwordx4 v[240:243], v1, s[44:47], s4 offen offset:0 sc1
    buffer_load_dwordx4 v[244:247], v1, s[44:47], s4 offen offset:1024 sc1
    v_smfmac_f32_16x16x64_bf16 v[92:95], v[28:31], v[248:255], v2
    buffer_load_dwordx4 v[248:251], v1, s[44:47], s4 offen offset:2048 sc1
    buffer_load_dwordx4 v[252:255], v1, s[44:47], s4 offen offset:3072 sc1
    s_cmp_lg_u32 s15, 0
    s_cbranch_scc1 L_stage_135
    s_mov_b32 m0, s100
    s_add_u32 s100, s100, 1024
    buffer_load_dwordx4 v15, s[64:67], s98 offen lds
    s_add_u32 s98, s98, s99
    s_mov_b32 m0, s100
    s_add_u32 s100, s100, 1024
    buffer_load_dwordx4 v15, s[64:67], s98 offen lds
    s_add_u32 s98, s98, s99
    s_cmp_eq_u32 s96, 0
    s_cbranch_scc1 L_stage_135
    s_mov_b32 m0, s100
    s_add_u32 s100, s100, 1024
    buffer_load_dwordx4 v15, s[64:67], s98 offen lds
    s_add_u32 s98, s98, s99
    s_mov_b32 m0, s100
    s_add_u32 s100, s100, 1024
    buffer_load_dwordx4 v15, s[64:67], s98 offen lds
    s_add_u32 s98, s98, s99
    s_mov_b32 m0, s100
    s_add_u32 s100, s100, 1024
    buffer_load_dwordx4 v15, s[64:67], s98 offen lds
    s_add_u32 s98, s98, s99
    s_mov_b32 m0, s100
    s_add_u32 s100, s100, 1024
    buffer_load_dwordx4 v15, s[64:67], s98 offen lds
    s_add_u32 s98, s98, s99
L_stage_135:
    s_branch L_npoll_136x
L_npoll_136:
    s_sub_u32 s14, s14, 1
    s_cbranch_scc1 L_end_1
    s_sleep 2
L_npoll_136x:
    ds_read_b32 v24, v7 offset:0
    s_waitcnt lgkmcnt(0)
    v_cmp_eq_f32 vcc, -1.0, v24
    s_cbranch_vccnz L_npoll_136
    ds_read2st64_b32 v[16:17], v6 offset0:0 offset1:1
    ds_read2st64_b32 v[18:19], v6 offset0:9 offset1:10
    ds_read2st64_b32 v[20:21], v6 offset0:18 offset1:19
    ds_read2st64_b32 v[22:23], v6 offset0:27 offset1:28
    v_add_f32_dpp v24, v24, v24 quad_perm:[1,0,3,2] row_mask:0xf bank_mask:0xf
    s_nop 1
    v_add_f32_dpp v24, v24, v24 quad_perm:[2,3,0,1] row_mask:0xf bank_mask:0xf
    s_nop 0
    v_rcp_f32 v25, v24
    s_waitcnt lgkmcnt(2)
    v_add_f32 v16, v16, v18
    v_add_f32 v17, v17, v19
    s_waitcnt lgkmcnt(0)
    v_add_f32 v20, v20, v22
    v_add_f32 v21, v21, v23
    v_add_f32 v16, v16, v20
    v_add_f32 v17, v17, v21
    v_maximum3_f32 v12, |v16|, |v17|, v12
    v_mul_f32 v16, v16, v25
    v_mul_f32 v17, v17, v25
    v_maximum3_f32 v13, v24, v25, v13
    v_cvt_pk_bf16_f32 v16, v16, v17
    ds_write_b32 v8, v16 offset:768
    s_mov_b64 exec, 1
    ds_add_u32 v10, v9 offset:10520
    s_mov_b64 exec, -1
L_opoll_137:
    s_sub_u32 s14, s14, 1
    s_cbranch_scc1 L_end_1
    ds_read_b32 v16, v10 offset:10520
    ds_read_b128 v[28:31], v4 offset:768
    s_waitcnt lgkmcnt(0)
    v_cmp_ne_u32 vcc, 4, v16
    s_cbranch_vccnz L_opoll_137
    s_waitcnt vmcnt(0)
    v_smfmac_f32_16x16x64_bf16 v[64:67], v[28:31], v[192:199], v2
    s_add_u32 s4, s8, 0xf0000
    buffer_load_dwordx4 v[192:195], v1, s[44:47], s4 offen offset:0 sc1
    buffer_load_dwordx4 v[196:199], v1, s[44:47], s4 offen offset:1024 sc1
    v_smfmac_f32_16x16x64_bf16 v[68:71], v[28:31], v[200:207], v2
    buffer_load_dwordx4 v[200:203], v1, s[44:47], s4 offen offset:2048 sc1
    buffer_load_dwordx4 v[204:207], v1, s[44:47], s4 offen offset:3072 sc1
    s_add_u32 s4, s4, 4096
    v_smfmac_f32_16x16x64_bf16 v[72:75], v[28:31], v[208:215], v2
    buffer_load_dwordx4 v[208:211], v1, s[44:47], s4 offen offset:0 sc1
    buffer_load_dwordx4 v[212:215], v1, s[44:47], s4 offen offset:1024 sc1
    v_smfmac_f32_16x16x64_bf16 v[76:79], v[28:31], v[216:223], v2
    buffer_load_dwordx4 v[216:219], v1, s[44:47], s4 offen offset:2048 sc1
    buffer_load_dwordx4 v[220:223], v1, s[44:47], s4 offen offset:3072 sc1
    s_add_u32 s4, s4, 4096
    v_smfmac_f32_16x16x64_bf16 v[80:83], v[28:31], v[224:231], v2
    buffer_load_dwordx4 v[224:227], v1, s[44:47], s4 offen offset:0 sc1
    buffer_load_dwordx4 v[228:231], v1, s[44:47], s4 offen offset:1024 sc1
    v_smfmac_f32_16x16x64_bf16 v[84:87], v[28:31], v[232:239], v2
    buffer_load_dwordx4 v[232:235], v1, s[44:47], s4 offen offset:2048 sc1
    buffer_load_dwordx4 v[236:239], v1, s[44:47], s4 offen offset:3072 sc1
    s_add_u32 s4, s4, 4096
    v_smfmac_f32_16x16x64_bf16 v[88:91], v[28:31], v[240:247], v2
    buffer_load_dwordx4 v[240:243], v1, s[44:47], s4 offen offset:0 sc1
    buffer_load_dwordx4 v[244:247], v1, s[44:47], s4 offen offset:1024 sc1
    v_smfmac_f32_16x16x64_bf16 v[92:95], v[28:31], v[248:255], v2
    buffer_load_dwordx4 v[248:251], v1, s[44:47], s4 offen offset:2048 sc1
    buffer_load_dwordx4 v[252:255], v1, s[44:47], s4 offen offset:3072 sc1
    s_cmp_lg_u32 s15, 0
    s_cbranch_scc1 L_stage_138
    s_cmp_eq_u32 s96, 0
    s_cbranch_scc1 L_stage_138
    s_mov_b32 m0, s100
    s_add_u32 s100, s100, 1024
    buffer_load_dwordx4 v15, s[64:67], s98 offen lds
    s_add_u32 s98, s98, s99
    s_mov_b32 m0, s100
    s_add_u32 s100, s100, 1024
    buffer_load_dwordx4 v15, s[64:67], s98 offen lds
    s_add_u32 s98, s98, s99
L_stage_138:
    v_lshrrev_b32 v16, 4, v0
    v_bfe_u32 v17, v0, 1, 3
    v_lshl_add_u32 v16, v16, 3, v17
    v_lshlrev_b32 v24, 2, v16
    v_add_u32 v24, 56320, v24
    v_and_b32 v17, 1, v0
    v_lshlrev_b32 v25, 10, v17
    v_lshl_add_u32 v25, v16, 4, v25
    v_add_u32 v25, 54272, v25
    v_add_u32 v23, 128, v25
    v_lshrrev_b32 v26, 4, v0
    v_mul_u32_u24 v26, 4160, v26
    v_and_b32 v27, 15, v0
    v_lshl_add_u32 v26, v27, 2, v26
    s_lshl_b32 s4, s9, 9
    s_add_u32 s4, s4, 37632
    v_add_u32 v26, s4, v26
    v_add_u32 v27, 2080, v26
    s_barrier
    ds_read_b32 v16, v24 offset:0
    ds_read_b32 v17, v24 offset:2304
    ds_read_b32 v18, v24 offset:4608
    ds_read_b32 v19, v24 offset:6912
    ds_read_b128 v[96:99], v25 offset:0
    ds_read_b128 v[100:103], v25 offset:512
    ds_read_b128 v[104:107], v25 offset:2304
    ds_read_b128 v[108:111], v25 offset:2816
    ds_read_b128 v[112:115], v25 offset:4608
    ds_read_b128 v[116:119], v25 offset:5120
    ds_read_b128 v[120:123], v25 offset:6912
    ds_read_b128 v[124:127], v25 offset:7424
    s_waitcnt lgkmcnt(8)
    v_add_f32 v16, v16, v17
    v_add_f32 v18, v18, v19
    v_add_f32 v16, v16, v18
    v_rcp_f32 v18, v16
    s_waitcnt lgkmcnt(4)
    v_pk_add_f32 v[96:97], v[96:97], v[104:105]
    v_pk_add_f32 v[98:99], v[98:99], v[106:107]
    v_pk_add_f32 v[100:101], v[100:101], v[108:109]
    v_pk_add_f32 v[102:103], v[102:103], v[110:111]
    s_waitcnt lgkmcnt(0)
    v_pk_add_f32 v[112:113], v[112:113], v[120:121]
    v_pk_add_f32 v[114:115], v[114:115], v[122:123]
    v_pk_add_f32 v[116:117], v[116:117], v[124:125]
    v_pk_add_f32 v[118:119], v[118:119], v[126:127]
    v_pk_add_f32 v[96:97], v[96:97], v[112:113]
    v_pk_add_f32 v[98:99], v[98:99], v[114:115]
    v_pk_add_f32 v[100:101], v[100:101], v[116:117]
    v_pk_add_f32 v[102:103], v[102:103], v[118:119]
    v_pk_mul_f32 v[104:105], v[96:97], v[18:19] op_sel_hi:[1,0]
    v_pk_mul_f32 v[106:107], v[98:99], v[18:19] op_sel_hi:[1,0]
    v_pk_mul_f32 v[108:109], v[100:101], v[18:19] op_sel_hi:[1,0]
    v_pk_mul_f32 v[110:111], v[102:103], v[18:19] op_sel_hi:[1,0]
    v_cvt_pk_bf16_f32 v28, v104, v105
    v_cvt_pk_bf16_f32 v29, v106, v107
    v_cvt_pk_bf16_f32 v30, v108, v109
    v_cvt_pk_bf16_f32 v31, v110, v111
    v_maximum3_f32 v13, v13, v16, v18
    s_waitcnt vmcnt(0)
    v_smfmac_f32_16x16x64_bf16 v[64:67], v[28:31], v[192:199], v2
    v_maximum3_f32 v12, v12, |v96|, |v97|
    v_smfmac_f32_16x16x64_bf16 v[68:71], v[28:31], v[200:207], v2
    v_maximum3_f32 v12, v12, |v98|, |v99|
    v_smfmac_f32_16x16x64_bf16 v[72:75], v[28:31], v[208:215], v2
    v_maximum3_f32 v12, v12, |v100|, |v101|
    v_smfmac_f32_16x16x64_bf16 v[76:79], v[28:31], v[216:223], v2
    v_maximum3_f32 v12, v12, |v102|, |v103|
    v_smfmac_f32_16x16x64_bf16 v[80:83], v[28:31], v[224:231], v2
    v_mov_b32 v18, 0x71800000
    v_smfmac_f32_16x16x64_bf16 v[84:87], v[28:31], v[232:239], v2
    v_mov_b32 v19, 0x53800000
    v_smfmac_f32_16x16x64_bf16 v[88:91], v[28:31], v[240:247], v2
    v_cmp_nle_f32 vcc, v12, v18
    v_smfmac_f32_16x16x64_bf16 v[92:95], v[28:31], v[248:255], v2
    v_cmp_nle_f32 s[4:5], v13, v19
    v_add_f32 v64, v64, v65
    v_add_f32 v66, v66, v67
    v_add_f32 v68, v68, v69
    v_add_f32 v70, v70, v71
    ds_write2_b32 v26, v64, v68 offset0:0 offset1:16
    ds_write2_b32 v27, v66, v70 offset0:0 offset1:16
    v_add_f32 v72, v72, v73
    v_add_f32 v74, v74, v75
    v_add_f32 v76, v76, v77
    v_add_f32 v78, v78, v79
    ds_write2_b32 v26, v72, v76 offset0:32 offset1:48
    ds_write2_b32 v27, v74, v78 offset0:32 offset1:48
    s_lshl_b32 s10, s15, 2
    v_mov_b32 v16, s10
    s_or_b64 vcc, vcc, s[4:5]
    s_and_b64 exec, exec, vcc
    ds_write_b32 v16, v9 offset:10536
    s_mov_b64 exec, -1
    v_add_f32 v80, v80, v81
    v_add_f32 v82, v82, v83
    v_add_f32 v84, v84, v85
    v_add_f32 v86, v86, v87
    ds_write2_b32 v26, v80, v84 offset0:64 offset1:80
    ds_write2_b32 v27, v82, v86 offset0:64 offset1:80
    v_add_f32 v88, v88, v89
    v_add_f32 v90, v90, v91
    v_add_f32 v92, v92, v93
    v_add_f32 v94, v94, v95
    ds_write2_b32 v26, v88, v92 offset0:96 offset1:112
    ds_write2_b32 v27, v90, v94 offset0:96 offset1:112
L_hepi_9:
    s_lshl_b32 s4, s15, 2
    v_mov_b32 v16, s4
    s_waitcnt lgkmcnt(0)
    s_barrier
    ds_read_b32 v16, v16 offset:10536
    s_waitcnt lgkmcnt(0)
    v_readfirstlane_b32 s4, v16
    s_cmp_gt_u32 s4, s7
    s_cbranch_scc1 L_slow_8
    s_branch L_th_141
L_epi_7:
    v_and_b32 v8, 31, v0
    v_lshrrev_b32 v9, 5, v0
    v_lshlrev_b32 v10, 4, v8
    v_add_u32 v11, 161792, v10
    ds_read_b128 v[56:59], v11
    ds_read_b128 v[60:63], v11 offset:512
    s_lshl_b32 s4, s3, 1
    v_add_u32 v12, s4, v9
    v_mul_u32_u24 v11, 1056, v12
    v_add_u32 v11, v11, v10
    s_waitcnt lgkmcnt(0)
    ds_read_b128 v[16:19], v11 offset:20736
    ds_read_b128 v[20:23], v11 offset:21248
    v_mul_u32_u24 v13, 2080, v12
    v_lshl_add_u32 v13, v8, 5, v13
    v_add_u32 v13, 37632, v13
    s_lshl_b32 s4, s2, 3
    s_sub_u32 s4, 34815, s4
    v_sub_u32 v12, s4, v12
    s_lshl_b32 s4, s15, 2
    v_mov_b32 v14, s4
    s_waitcnt lgkmcnt(0)
    v_lshlrev_b32 v40, 16, v16
    v_and_b32 v41, 0xffff0000, v16
    v_lshlrev_b32 v42, 16, v17
    v_and_b32 v43, 0xffff0000, v17
    v_lshlrev_b32 v44, 16, v18
    v_and_b32 v45, 0xffff0000, v18
    v_lshlrev_b32 v46, 16, v19
    v_and_b32 v47, 0xffff0000, v19
    v_lshlrev_b32 v48, 16, v20
    v_and_b32 v49, 0xffff0000, v20
    v_lshlrev_b32 v50, 16, v21
    v_and_b32 v51, 0xffff0000, v21
    v_lshlrev_b32 v52, 16, v22
    v_and_b32 v53, 0xffff0000, v22
    v_lshlrev_b32 v54, 16, v23
    v_and_b32 v55, 0xffff0000, v23
    v_dot2_f32_bf16 v15, v56, s95, 0
    v_dot2_f32_bf16 v15, v57, s95, v15
    v_dot2_f32_bf16 v15, v58, s95, v15
    v_dot2_f32_bf16 v15, v59, s95, v15
    v_dot2_f32_bf16 v15, v60, s95, v15
    v_dot2_f32_bf16 v15, v61, s95, v15
    v_dot2_f32_bf16 v15, v62, s95, v15
    v_dot2_f32_bf16 v15, v63, s95, v15
    s_nop 2
    v_add_f32_dpp v15, v15, v15 quad_perm:[1,0,3,2] row_mask:0xf bank_mask:0xf
    s_nop 1
    v_add_f32_dpp v15, v15, v15 quad_perm:[2,3,0,1] row_mask:0xf bank_mask:0xf
    s_nop 1
    v_add_f32_dpp v15, v15, v15 row_half_mirror row_mask:0xf bank_mask:0xf
    s_nop 1
    v_add_f32_dpp v15, v15, v15 row_mirror row_mask:0xf bank_mask:0xf
    v_mov_b32 v16, v15
    s_nop 1
    v_permlane16_swap_b32 v15, v16
    v_add_f32 v15, v15, v16
    s_barrier
    ds_read_b32 v16, v14 offset:10536
    ds_read_b128 v[24:27], v13
    ds_read_b128 v[28:31], v13 offset:16
    ds_read_b128 v[32:35], v13 offset:1024
    ds_read_b128 v[36:39], v13 offset:1040
    s_waitcnt lgkmcnt(4)
    v_readfirstlane_b32 s4, v16
    s_cmp_gt_u32 s4, s7
    s_cbranch_scc1 L_slow_8
    s_waitcnt lgkmcnt(2)
    v_pk_add_f32 v[24:25], v[24:25], v[40:41]
    v_pk_add_f32 v[26:27], v[26:27], v[42:43]
    v_pk_add_f32 v[28:29], v[28:29], v[44:45]
    v_pk_add_f32 v[30:31], v[30:31], v[46:47]
    v_cvt_pk_bf16_f32 v64, v24, v25
    v_cvt_pk_bf16_f32 v65, v26, v27
    v_cvt_pk_bf16_f32 v66, v28, v29
    v_cvt_pk_bf16_f32 v67, v30, v31
    s_waitcnt lgkmcnt(0)
    v_pk_add_f32 v[32:33], v[32:33], v[48:49]
    v_pk_add_f32 v[34:35], v[34:35], v[50:51]
    v_pk_add_f32 v[36:37], v[36:37], v[52:53]
    v_pk_add_f32 v[38:39], v[38:39], v[54:55]
    v_cvt_pk_bf16_f32 v68, v32, v33
    v_cvt_pk_bf16_f32 v69, v34, v35
    v_cvt_pk_bf16_f32 v70, v36, v37
    v_cvt_pk_bf16_f32 v71, v38, v39
    v_dot2_f32_bf16 v124, v64, s95, 0
    v_dot2_f32_bf16 v125, v64, v64, 0
    v_dot2_f32_bf16 v126, v64, v56, 0
    v_dot2_f32_bf16 v124, v65, s95, v124
    v_dot2_f32_bf16 v125, v65, v65, v125
    v_dot2_f32_bf16 v126, v65, v57, v126
    v_dot2_f32_bf16 v124, v66, s95, v124
    v_dot2_f32_bf16 v125, v66, v66, v125
    v_dot2_f32_bf16 v126, v66, v58, v126
    v_dot2_f32_bf16 v124, v67, s95, v124
    v_dot2_f32_bf16 v125, v67, v67, v125
    v_dot2_f32_bf16 v126, v67, v59, v126
    v_dot2_f32_bf16 v124, v68, s95, v124
    v_dot2_f32_bf16 v125, v68, v68, v125
    v_dot2_f32_bf16 v126, v68, v60, v126
    v_dot2_f32_bf16 v124, v69, s95, v124
    v_dot2_f32_bf16 v125, v69, v69, v125
    v_dot2_f32_bf16 v126, v69, v61, v126
    v_dot2_f32_bf16 v124, v70, s95, v124
    v_dot2_f32_bf16 v125, v70, v70, v125
    v_dot2_f32_bf16 v126, v70, v62, v126
    v_dot2_f32_bf16 v124, v71, s95, v124
    v_dot2_f32_bf16 v125, v71, v71, v125
    v_dot2_f32_bf16 v126, v71, v63, v126
    v_lshlrev_b32 v72, 16, v64
    v_and_b32 v73, 0xffff0000, v64
    v_lshlrev_b32 v74, 16, v65
    v_add_f32_dpp v124, v124, v124 quad_perm:[1,0,3,2] row_mask:0xf bank_mask:0xf
    v_add_f32_dpp v125, v125, v125 quad_perm:[1,0,3,2] row_mask:0xf bank_mask:0xf
    v_add_f32_dpp v126, v126, v126 quad_perm:[1,0,3,2] row_mask:0xf bank_mask:0xf
    v_add_f32_dpp v124, v124, v124 quad_perm:[2,3,0,1] row_mask:0xf bank_mask:0xf
    v_add_f32_dpp v125, v125, v125 quad_perm:[2,3,0,1] row_mask:0xf bank_mask:0xf
    v_add_f32_dpp v126, v126, v126 quad_perm:[2,3,0,1] row_mask:0xf bank_mask:0xf
    v_add_f32_dpp v124, v124, v124 row_half_mirror row_mask:0xf bank_mask:0xf
    v_add_f32_dpp v125, v125, v125 row_half_mirror row_mask:0xf bank_mask:0xf
    v_add_f32_dpp v126, v126, v126 row_half_mirror row_mask:0xf bank_mask:0xf
    v_add_f32_dpp v124, v124, v124 row_mirror row_mask:0xf bank_mask:0xf
    v_add_f32_dpp v125, v125, v125 row_mirror row_mask:0xf bank_mask:0xf
    v_add_f32_dpp v126, v126, v126 row_mirror row_mask:0xf bank_mask:0xf
    v_mov_b32 v16, v124
    v_mov_b32 v17, v125
    v_mov_b32 v18, v126
    v_permlane16_swap_b32 v124, v16
    v_permlane16_swap_b32 v125, v17
    v_permlane16_swap_b32 v126, v18
    v_add_f32 v124, v124, v16
    v_add_f32 v125, v125, v17
    v_add_f32 v126, v126, v18
    v_mul_f32 v122, 0x3b000000, v124
    v_mul_f32 v120, 0x3b000000, v125
    v_fma_f32 v120, -v122, v122, v120
    v_max_f32 v120, 0, v120
    v_cvt_pk_bf16_f32 v121, v122, v120
    v_and_b32 v120, 0xffff0000, v121
    v_add_f32 v120, 0x3727c5ac, v120
    v_cvt_pk_bf16_f32 v120, v120, v120
    v_lshlrev_b32 v120, 16, v120
    v_sqrt_f32 v120, v120
    v_lshlrev_b32 v122, 16, v121
    v_cvt_pk_bf16_f32 v120, v120, v120
    v_lshlrev_b32 v120, 16, v120
    v_rcp_f32 v120, v120
    v_sub_f32 v123, 0, v122
    v_mul_f32 v122, -v122, v120
    v_mul_f32 v16, v126, v120
    v_fmac_f32 v16, v122, v15
    v_cvt_pk_bf16_f32 v16, v16, v16
    v_ashrrev_i32 v17, 31, v16
    v_or_b32 v17, 0x80000000, v17
    v_xor_b32 v16, v16, v17
    v_and_b32 v16, 0xffff0000, v16
    v_or_b32 v16, v16, v12
    v_mov_b32 v17, 0
    v_mov_b32 v18, 1
    s_mov_b32 exec_lo, 1
    s_mov_b32 exec_hi, 1
    ds_max_u32 v14, v16 offset:10528
    s_mov_b32 exec_hi, 0
    ds_add_rtn_u32 v19, v17, v18 offset:10560
    ds_read_b32 v20, v14 offset:10528
    s_mov_b64 exec, -1
    s_lshl_b32 s4, s2, 6
    s_lshl_b32 s5, s15, 14
    s_add_u32 s4, s4, s5
    s_add_u32 s4, s4, 0x244000
    s_lshl_b32 s10, s15, 2
    s_add_u32 s10, s10, 3
    v_and_b32 v75, 0xffff0000, v65
    v_lshlrev_b32 v76, 16, v66
    v_and_b32 v77, 0xffff0000, v66
    v_lshlrev_b32 v78, 16, v67
    v_and_b32 v79, 0xffff0000, v67
    v_lshlrev_b32 v80, 16, v68
    v_and_b32 v81, 0xffff0000, v68
    v_lshlrev_b32 v82, 16, v69
    v_and_b32 v83, 0xffff0000, v69
    v_lshlrev_b32 v84, 16, v70
    v_and_b32 v85, 0xffff0000, v70
    v_lshlrev_b32 v86, 16, v71
    v_and_b32 v87, 0xffff0000, v71
    s_waitcnt lgkmcnt(0)
    v_readfirstlane_b32 s5, v19
    s_cmp_lg_u32 s5, s10
    s_cbranch_scc1 L_nlast_143
    s_mov_b64 exec, 1
    buffer_store_dword v20, off, s[44:47], s4 sc1
    s_mov_b64 exec, -1
L_nlast_143:
    s_add_u32 s10, s10, 1
    v_pk_add_f32 v[96:97], v[72:73], v[122:123] op_sel:[0,1] op_sel_hi:[1,1]
    v_pk_add_f32 v[98:99], v[74:75], v[122:123] op_sel:[0,1] op_sel_hi:[1,1]
    v_pk_add_f32 v[100:101], v[76:77], v[122:123] op_sel:[0,1] op_sel_hi:[1,1]
    v_pk_add_f32 v[102:103], v[78:79], v[122:123] op_sel:[0,1] op_sel_hi:[1,1]
    v_cvt_pk_bf16_f32 v88, v96, v97
    v_cvt_pk_bf16_f32 v89, v98, v99
    v_cvt_pk_bf16_f32 v90, v100, v101
    v_cvt_pk_bf16_f32 v91, v102, v103
    v_lshlrev_b32 v96, 16, v88
    v_and_b32 v97, 0xffff0000, v88
    v_lshlrev_b32 v98, 16, v89
    v_and_b32 v99, 0xffff0000, v89
    v_lshlrev_b32 v100, 16, v90
    v_and_b32 v101, 0xffff0000, v90
    v_lshlrev_b32 v102, 16, v91
    v_and_b32 v103, 0xffff0000, v91
    v_pk_mul_f32 v[96:97], v[96:97], v[120:121] op_sel_hi:[1,0]
    v_pk_mul_f32 v[98:99], v[98:99], v[120:121] op_sel_hi:[1,0]
    v_pk_mul_f32 v[100:101], v[100:101], v[120:121] op_sel_hi:[1,0]
    v_pk_mul_f32 v[102:103], v[102:103], v[120:121] op_sel_hi:[1,0]
    v_cvt_pk_bf16_f32 v88, v96, v97
    v_cvt_pk_bf16_f32 v89, v98, v99
    v_cvt_pk_bf16_f32 v90, v100, v101
    v_cvt_pk_bf16_f32 v91, v102, v103
    v_pk_add_f32 v[104:105], v[80:81], v[122:123] op_sel:[0,1] op_sel_hi:[1,1]
    v_pk_add_f32 v[106:107], v[82:83], v[122:123] op_sel:[0,1] op_sel_hi:[1,1]
    v_pk_add_f32 v[108:109], v[84:85], v[122:123] op_sel:[0,1] op_sel_hi:[1,1]
    v_pk_add_f32 v[110:111], v[86:87], v[122:123] op_sel:[0,1] op_sel_hi:[1,1]
    v_cvt_pk_bf16_f32 v92, v104, v105
    v_cvt_pk_bf16_f32 v93, v106, v107
    v_cvt_pk_bf16_f32 v94, v108, v109
    v_cvt_pk_bf16_f32 v95, v110, v111
    v_lshlrev_b32 v104, 16, v92
    v_and_b32 v105, 0xffff0000, v92
    v_lshlrev_b32 v106, 16, v93
    v_and_b32 v107, 0xffff0000, v93
    v_lshlrev_b32 v108, 16, v94
    v_and_b32 v109, 0xffff0000, v94
    v_lshlrev_b32 v110, 16, v95
    v_and_b32 v111, 0xffff0000, v95
    v_pk_mul_f32 v[104:105], v[104:105], v[120:121] op_sel_hi:[1,0]
    v_pk_mul_f32 v[106:107], v[106:107], v[120:121] op_sel_hi:[1,0]
    v_pk_mul_f32 v[108:109], v[108:109], v[120:121] op_sel_hi:[1,0]
    v_pk_mul_f32 v[110:111], v[110:111], v[120:121] op_sel_hi:[1,0]
    v_cvt_pk_bf16_f32 v92, v104, v105
    v_cvt_pk_bf16_f32 v93, v106, v107
    v_cvt_pk_bf16_f32 v94, v108, v109
    v_cvt_pk_bf16_f32 v95, v110, v111
L_cw_144:
    s_sub_u32 s14, s14, 1
    s_cbranch_scc1 L_end_1
    ds_read_b32 v19, v17 offset:10560
    ds_read_b32 v20, v14 offset:10528
    s_lshl_b32 s4, s2, 10
    s_lshl_b32 s5, s15, 19
    s_add_u32 s4, s4, s5
    s_add_u32 s4, s4, 0x140000
    s_add_u32 s5, s4, 0x40000
    s_waitcnt lgkmcnt(0)
    v_cmp_ne_u32 vcc, s10, v19
    s_cbranch_vccnz L_cw_144
    v_cmp_eq_u32 vcc, v20, v16
    s_not_b64 s[32:33], vcc
    s_cbranch_vccz L_notbest_145
    s_mov_b64 exec, vcc
    v_min_u32 v24, -2, v88
    v_min_u32 v25, -2, v89
    v_min_u32 v26, -2, v90
    v_min_u32 v27, -2, v91
    v_min_u32 v28, -2, v92
    v_min_u32 v29, -2, v93
    v_min_u32 v30, -2, v94
    v_min_u32 v31, -2, v95
    buffer_store_dwordx4 v[24:27], v10, s[44:47], s4 offen sc1
    buffer_store_dwordx4 v[28:31], v10, s[44:47], s4 offen offset:512 sc1
    v_min_u32 v32, -2, v64
    v_min_u32 v33, -2, v65
    v_min_u32 v34, -2, v66
    v_min_u32 v35, -2, v67
    v_min_u32 v36, -2, v68
    v_min_u32 v37, -2, v69
    v_min_u32 v38, -2, v70
    v_min_u32 v39, -2, v71
    buffer_store_dwordx4 v[32:35], v10, s[44:47], s5 offen sc1
    buffer_store_dwordx4 v[36:39], v10, s[44:47], s5 offen offset:512 sc1
    s_mov_b64 exec, -1
L_notbest_145:
    v_lshlrev_b32 v96, 16, v88
    v_and_b32 v97, 0xffff0000, v88
    v_lshlrev_b32 v98, 16, v89
    v_and_b32 v99, 0xffff0000, v89
    v_lshlrev_b32 v100, 16, v90
    v_and_b32 v101, 0xffff0000, v90
    v_lshlrev_b32 v102, 16, v91
    v_and_b32 v103, 0xffff0000, v91
    v_lshlrev_b32 v104, 16, v92
    v_and_b32 v105, 0xffff0000, v92
    v_lshlrev_b32 v106, 16, v93
    v_and_b32 v107, 0xffff0000, v93
    v_lshlrev_b32 v108, 16, v94
    v_and_b32 v109, 0xffff0000, v94
    v_lshlrev_b32 v110, 16, v95
    v_and_b32 v111, 0xffff0000, v95
    v_pk_add_f32 v[72:73], v[72:73], v[96:97]
    v_pk_add_f32 v[74:75], v[74:75], v[98:99]
    v_pk_add_f32 v[76:77], v[76:77], v[100:101]
    v_pk_add_f32 v[78:79], v[78:79], v[102:103]
    v_pk_add_f32 v[80:81], v[80:81], v[104:105]
    v_pk_add_f32 v[82:83], v[82:83], v[106:107]
    v_pk_add_f32 v[84:85], v[84:85], v[108:109]
    v_pk_add_f32 v[86:87], v[86:87], v[110:111]
    v_cvt_pk_bf16_f32 v112, v72, v73
    v_cvt_pk_bf16_f32 v113, v74, v75
    v_cvt_pk_bf16_f32 v114, v76, v77
    v_cvt_pk_bf16_f32 v115, v78, v79
    v_cvt_pk_bf16_f32 v116, v80, v81
    v_cvt_pk_bf16_f32 v117, v82, v83
    v_cvt_pk_bf16_f32 v118, v84, v85
    v_cvt_pk_bf16_f32 v119, v86, v87
    ds_write_b128 v11, v[112:115] offset:20736
    ds_write_b128 v11, v[116:119] offset:21248
    s_cmp_eq_u32 s15, 0
    s_cbranch_scc1 L_e1_146
    v_lshl_add_u32 v10, v9, 10, v10
    s_add_u32 s4, s6, s3
    s_lshl_b32 s4, s4, 10
    s_mov_b64 exec, s[32:33]
    buffer_store_dwordx4 v[112:115], v10, s[52:55], s4 offen sc1
    buffer_store_dwordx4 v[116:119], v10, s[52:55], s4 offen offset:512 sc1
    s_mov_b64 exec, 1
    ds_add_u32 v17, v18 offset:10596
    s_mov_b64 exec, -1
    s_mov_b64 exec, -1
    s_branch L_e2_147
L_e1_146:
    s_mov_b64 exec, 1
    ds_add_u32 v17, v18 offset:10596
    s_mov_b64 exec, -1
    v_dot2_f32_bf16 v124, v112, s95, 0
    v_dot2_f32_bf16 v125, v112, v112, 0
    v_dot2_f32_bf16 v124, v113, s95, v124
    v_dot2_f32_bf16 v125, v113, v113, v125
    v_dot2_f32_bf16 v124, v114, s95, v124
    v_dot2_f32_bf16 v125, v114, v114, v125
    v_dot2_f32_bf16 v124, v115, s95, v124
    v_dot2_f32_bf16 v125, v115, v115, v125
    v_dot2_f32_bf16 v124, v116, s95, v124
    v_dot2_f32_bf16 v125, v116, v116, v125
    v_dot2_f32_bf16 v124, v117, s95, v124
    v_dot2_f32_bf16 v125, v117, v117, v125
    v_dot2_f32_bf16 v124, v118, s95, v124
    v_dot2_f32_bf16 v125, v118, v118, v125
    v_dot2_f32_bf16 v124, v119, s95, v124
    v_dot2_f32_bf16 v125, v119, v119, v125
    v_lshlrev_b32 v72, 16, v112
    v_and_b32 v73, 0xffff0000, v112
    v_lshlrev_b32 v74, 16, v113
    v_add_f32_dpp v124, v124, v124 quad_perm:[1,0,3,2] row_mask:0xf bank_mask:0xf
    v_add_f32_dpp v125, v125, v125 quad_perm:[1,0,3,2] row_mask:0xf bank_mask:0xf
    v_and_b32 v75, 0xffff0000, v113
    v_add_f32_dpp v124, v124, v124 quad_perm:[2,3,0,1] row_mask:0xf bank_mask:0xf
    v_add_f32_dpp v125, v125, v125 quad_perm:[2,3,0,1] row_mask:0xf bank_mask:0xf
    v_lshlrev_b32 v76, 16, v114
    v_add_f32_dpp v124, v124, v124 row_half_mirror row_mask:0xf bank_mask:0xf
    v_add_f32_dpp v125, v125, v125 row_half_mirror row_mask:0xf bank_mask:0xf
    v_and_b32 v77, 0xffff0000, v114
    v_add_f32_dpp v124, v124, v124 row_mirror row_mask:0xf bank_mask:0xf
    v_add_f32_dpp v125, v125, v125 row_mirror row_mask:0xf bank_mask:0xf
    v_mov_b32 v126, v124
    v_mov_b32 v127, v125
    v_lshlrev_b32 v78, 16, v115
    v_permlane16_swap_b32 v124, v126
    v_permlane16_swap_b32 v125, v127
    v_add_f32 v124, v124, v126
    v_add_f32 v125, v125, v127
    v_and_b32 v79, 0xffff0000, v115
    v_lshlrev_b32 v80, 16, v116
    v_and_b32 v81, 0xffff0000, v116
    v_lshlrev_b32 v82, 16, v117
    v_and_b32 v83, 0xffff0000, v117
    v_lshlrev_b32 v84, 16, v118
    v_and_b32 v85, 0xffff0000, v118
    v_lshlrev_b32 v86, 16, v119
    v_and_b32 v87, 0xffff0000, v119
    v_mul_f32 v122, 0x3b000000, v124
    v_mul_f32 v120, 0x3b000000, v125
    v_fma_f32 v120, -v122, v122, v120
    v_max_f32 v120, 0, v120
    v_cvt_pk_bf16_f32 v121, v122, v120
    v_and_b32 v120, 0xffff0000, v121
    v_add_f32 v120, 0x3727c5ac, v120
    v_cvt_pk_bf16_f32 v120, v120, v120
    v_lshlrev_b32 v120, 16, v120
    v_sqrt_f32 v120, v120
    v_lshlrev_b32 v122, 16, v121
    v_cvt_pk_bf16_f32 v120, v120, v120
    v_lshlrev_b32 v120, 16, v120
    v_rcp_f32 v120, v120
    v_sub_f32 v123, 0, v122
    v_mul_f32 v122, -v122, v120
    v_pk_add_f32 v[72:73], v[72:73], v[122:123] op_sel:[0,1] op_sel_hi:[1,1]
    v_pk_add_f32 v[74:75], v[74:75], v[122:123] op_sel:[0,1] op_sel_hi:[1,1]
    v_pk_add_f32 v[76:77], v[76:77], v[122:123] op_sel:[0,1] op_sel_hi:[1,1]
    v_pk_add_f32 v[78:79], v[78:79], v[122:123] op_sel:[0,1] op_sel_hi:[1,1]
    v_cvt_pk_bf16_f32 v88, v72, v73
    v_cvt_pk_bf16_f32 v89, v74, v75
    v_cvt_pk_bf16_f32 v90, v76, v77
    v_cvt_pk_bf16_f32 v91, v78, v79
    v_lshlrev_b32 v72, 16, v88
    v_and_b32 v73, 0xffff0000, v88
    v_lshlrev_b32 v74, 16, v89
    v_and_b32 v75, 0xffff0000, v89
    v_lshlrev_b32 v76, 16, v90
    v_and_b32 v77, 0xffff0000, v90
    v_lshlrev_b32 v78, 16, v91
    v_and_b32 v79, 0xffff0000, v91
    v_pk_mul_f32 v[72:73], v[72:73], v[120:121] op_sel_hi:[1,0]
    v_pk_mul_f32 v[74:75], v[74:75], v[120:121] op_sel_hi:[1,0]
    v_pk_mul_f32 v[76:77], v[76:77], v[120:121] op_sel_hi:[1,0]
    v_pk_mul_f32 v[78:79], v[78:79], v[120:121] op_sel_hi:[1,0]
    v_cvt_pk_bf16_f32 v88, v72, v73
    v_cvt_pk_bf16_f32 v89, v74, v75
    v_cvt_pk_bf16_f32 v90, v76, v77
    v_cvt_pk_bf16_f32 v91, v78, v79
    v_pk_add_f32 v[80:81], v[80:81], v[122:123] op_sel:[0,1] op_sel_hi:[1,1]
    v_pk_add_f32 v[82:83], v[82:83], v[122:123] op_sel:[0,1] op_sel_hi:[1,1]
    v_pk_add_f32 v[84:85], v[84:85], v[122:123] op_sel:[0,1] op_sel_hi:[1,1]
    v_pk_add_f32 v[86:87], v[86:87], v[122:123] op_sel:[0,1] op_sel_hi:[1,1]
    v_cvt_pk_bf16_f32 v92, v80, v81
    v_cvt_pk_bf16_f32 v93, v82, v83
    v_cvt_pk_bf16_f32 v94, v84, v85
    v_cvt_pk_bf16_f32 v95, v86, v87
    v_lshlrev_b32 v80, 16, v92
    v_and_b32 v81, 0xffff0000, v92
    v_lshlrev_b32 v82, 16, v93
    v_and_b32 v83, 0xffff0000, v93
    v_lshlrev_b32 v84, 16, v94
    v_and_b32 v85, 0xffff0000, v94
    v_lshlrev_b32 v86, 16, v95
    v_and_b32 v87, 0xffff0000, v95
    v_pk_mul_f32 v[80:81], v[80:81], v[120:121] op_sel_hi:[1,0]
    v_pk_mul_f32 v[82:83], v[82:83], v[120:121] op_sel_hi:[1,0]
    v_pk_mul_f32 v[84:85], v[84:85], v[120:121] op_sel_hi:[1,0]
    v_pk_mul_f32 v[86:87], v[86:87], v[120:121] op_sel_hi:[1,0]
    v_cvt_pk_bf16_f32 v92, v80, v81
    v_cvt_pk_bf16_f32 v93, v82, v83
    v_cvt_pk_bf16_f32 v94, v84, v85
    v_cvt_pk_bf16_f32 v95, v86, v87
    ds_write_b128 v11, v[88:91] offset:12288
    ds_write_b128 v11, v[92:95] offset:12800
L_e2_147:
    s_mov_b64 exec, 1
    ds_add_u32 v17, v18 offset:10588
    s_mov_b64 exec, -1
    s_cmp_lg_u32 s15, 0
    s_cbranch_scc1 L_fin_2
    s_mov_b32 s15, 1
    s_mov_b32 s7, 0
    s_branch L_ctop_15
L_th_141:
    s_cmp_lt_u32 s15, 1
    s_cbranch_scc0 L_tnw_152
    s_add_u32 s4, s8, 0x0
    buffer_load_dwordx4 v[128:131], v1, s[44:47], s4 offen offset:0 sc1
    buffer_load_dwordx4 v[132:135], v1, s[44:47], s4 offen offset:1024 sc1
    buffer_load_dwordx4 v[136:139], v1, s[44:47], s4 offen offset:2048 sc1
    buffer_load_dwordx4 v[140:143], v1, s[44:47], s4 offen offset:3072 sc1
    s_add_u32 s4, s4, 4096
    buffer_load_dwordx4 v[144:147], v1, s[44:47], s4 offen offset:0 sc1
    buffer_load_dwordx4 v[148:151], v1, s[44:47], s4 offen offset:1024 sc1
    buffer_load_dwordx4 v[152:155], v1, s[44:47], s4 offen offset:2048 sc1
    buffer_load_dwordx4 v[156:159], v1, s[44:47], s4 offen offset:3072 sc1
    s_add_u32 s4, s4, 4096
    buffer_load_dwordx4 v[160:163], v1, s[44:47], s4 offen offset:0 sc1
    buffer_load_dwordx4 v[164:167], v1, s[44:47], s4 offen offset:1024 sc1
    buffer_load_dwordx4 v[168:171], v1, s[44:47], s4 offen offset:2048 sc1
    buffer_load_dwordx4 v[172:175], v1, s[44:47], s4 offen offset:3072 sc1
    s_add_u32 s4, s4, 4096
    buffer_load_dwordx4 v[176:179], v1, s[44:47], s4 offen offset:0 sc1
    buffer_load_dwordx4 v[180:183], v1, s[44:47], s4 offen offset:1024 sc1
    buffer_load_dwordx4 v[184:187], v1, s[44:47], s4 offen offset:2048 sc1
    buffer_load_dwordx4 v[188:191], v1, s[44:47], s4 offen offset:3072 sc1
L_tnw_152:
    s_cmp_eq_u32 s3, 7
    s_cbranch_scc1 L_tw7_142
    s_cmp_lg_u32 s15, 0
    s_cbranch_scc1 L_tnkv_148
    s_cmp_ge_u32 s3, 6
    s_cbranch_scc1 L_tnkv_148
    ds_read_b64_tr_b16 v[64:65], v14 offset:0
    ds_read_b64_tr_b16 v[66:67], v14 offset:64
    ds_read_b64_tr_b16 v[68:69], v14 offset:1024
    ds_read_b64_tr_b16 v[70:71], v14 offset:1088
    ds_read_b64_tr_b16 v[72:73], v14 offset:2048
    ds_read_b64_tr_b16 v[74:75], v14 offset:2112
    ds_read_b64_tr_b16 v[76:77], v14 offset:3072
    ds_read_b64_tr_b16 v[78:79], v14 offset:3136
    ds_read_b64_tr_b16 v[80:81], v14 offset:4096
    ds_read_b64_tr_b16 v[82:83], v14 offset:4160
    ds_read_b64_tr_b16 v[84:85], v14 offset:5120
    ds_read_b64_tr_b16 v[86:87], v14 offset:5184
    ds_read_b64_tr_b16 v[88:89], v14 offset:6144
    ds_read_b64_tr_b16 v[90:91], v14 offset:6208
    ds_read_b64_tr_b16 v[92:93], v14 offset:7168
    ds_read_b64_tr_b16 v[94:95], v14 offset:7232
    ds_read_b64_tr_b16 v[96:97], v14 offset:8192
    ds_read_b64_tr_b16 v[98:99], v14 offset:8256
    ds_read_b64_tr_b16 v[100:101], v14 offset:9216
    ds_read_b64_tr_b16 v[102:103], v14 offset:9280
    ds_read_b64_tr_b16 v[104:105], v14 offset:10240
    ds_read_b64_tr_b16 v[106:107], v14 offset:10304
    ds_read_b64_tr_b16 v[108:109], v14 offset:11264
    ds_read_b64_tr_b16 v[110:111], v14 offset:11328
    ds_read_b64_tr_b16 v[112:113], v14 offset:12288
    ds_read_b64_tr_b16 v[114:115], v14 offset:12352
    ds_read_b64_tr_b16 v[116:117], v14 offset:13312
    ds_read_b64_tr_b16 v[118:119], v14 offset:13376
    ds_read_b64_tr_b16 v[120:121], v14 offset:14336
    ds_read_b64_tr_b16 v[122:123], v14 offset:14400
    ds_read_b64_tr_b16 v[124:125], v14 offset:15360
    ds_read_b64_tr_b16 v[126:127], v14 offset:15424
    s_lshl_b32 s4, s9, 8
    s_add_u32 s4, s4, 11776
    v_lshrrev_b32 v17, 4, v0
    v_bfe_u32 v16, v0, 3, 1
    v_lshlrev_b32 v20, 7, v16
    v_lshl_add_u32 v20, v17, 5, v20
    v_and_b32 v18, 7, v0
    v_lshl_add_u32 v20, v18, 1, v20
    v_lshlrev_b32 v23, 9, v16
    v_lshl_add_u32 v23, v18, 4, v23
    v_and_b32 v18, 15, v0
    v_lshlrev_b32 v18, 4, v18
    v_lshl_add_u32 v19, v17, 2, v18
    s_cmp_eq_u32 s3, 4
    s_cselect_b64 vcc, -1, 0
    s_cselect_b32 s5, 16, 2
    v_cndmask_b32 v20, v19, v20, vcc
    v_cndmask_b32 v23, v18, v23, vcc
    v_add_u32 v20, s4, v20
    v_add_u32 v21, s5, v20
    v_add_u32 v22, s4, v18
    v_mov_b32 v16, 0
L_lw_154:
    s_sub_u32 s14, s14, 1
    s_cbranch_scc1 L_end_1
    ds_read_b32 v17, v16 offset:10588
    s_waitcnt lgkmcnt(0)
    v_cmp_ne_u32 vcc, 8, v17
    s_cbranch_vccnz L_lw_154
    ds_read_b128 v[32:35], v3 offset:0
    ds_read_b128 v[36:39], v3 offset:128
    ds_read_b128 v[40:43], v3 offset:256
    ds_read_b128 v[44:47], v3 offset:384
    ds_read_b128 v[48:51], v3 offset:512
    ds_read_b128 v[52:55], v3 offset:640
    ds_read_b128 v[56:59], v3 offset:768
    ds_read_b128 v[60:63], v3 offset:896
    v_mov_b32 v28, 0
    v_mov_b32 v29, 0
    v_mov_b32 v30, 0
    v_mov_b32 v31, 0
    s_cmp_eq_u32 s3, 4
    s_cselect_b32 s10, 0x3eb8aa3b, 1.0
    s_waitcnt lgkmcnt(7)
    v_smfmac_f32_16x16x64_bf16 v[28:31], v[32:35], v[64:71], v2
    s_waitcnt lgkmcnt(6)
    v_smfmac_f32_16x16x64_bf16 v[28:31], v[36:39], v[72:79], v2
    s_waitcnt lgkmcnt(5)
    v_smfmac_f32_16x16x64_bf16 v[28:31], v[40:43], v[80:87], v2
    s_waitcnt lgkmcnt(4)
    v_smfmac_f32_16x16x64_bf16 v[28:31], v[44:47], v[88:95], v2
    s_waitcnt lgkmcnt(3)
    v_smfmac_f32_16x16x64_bf16 v[28:31], v[48:51], v[96:103], v2
    s_waitcnt lgkmcnt(2)
    v_smfmac_f32_16x16x64_bf16 v[28:31], v[52:55], v[104:111], v2
    s_waitcnt lgkmcnt(1)
    v_smfmac_f32_16x16x64_bf16 v[28:31], v[56:59], v[112:119], v2
    s_waitcnt lgkmcnt(0)
    v_smfmac_f32_16x16x64_bf16 v[28:31], v[60:63], v[120:127], v2
    s_nop 7
    v_add_f32 v28, v28, v29
    v_add_f32 v30, v30, v31
    v_mul_f32 v28, s10, v28
    v_mul_f32 v30, s10, v30
    v_cvt_pk_bf16_f32 v28, v28, v30
    ds_write_b16 v20, v28
    ds_write_b16_d16_hi v21, v28
    ds_read_b128 v[16:19], v22
    s_lshr_b32 s4, s2, 2
    s_lshl_b32 s4, s4, 10
    s_and_b32 s5, s2, 3
    s_lshl_b32 s5, s5, 7
    s_add_u32 s4, s4, s5
    s_lshl_b32 s5, s2, 8
    s_add_u32 s5, s5, 0x10000
    s_cmp_eq_u32 s3, 4
    s_cselect_b32 s4, s4, s5
    s_add_u32 s4, s4, 0x120000
    s_mov_b64 exec, 0xffff
    s_waitcnt lgkmcnt(0)
    v_min_u32 v16, -2, v16
    v_min_u32 v17, -2, v17
    v_min_u32 v18, -2, v18
    v_min_u32 v19, -2, v19
    buffer_store_dwordx4 v[16:19], v23, s[44:47], s4 offen sc1
    s_mov_b64 exec, -1
L_tnkv_148:
L_tb_149:
    s_cmp_eq_u32 s96, 0
    s_cbranch_scc1 L_tfix_150
    v_bfe_u32 v16, v0, 2, 1
    v_bfe_u32 v17, v0, 3, 1
    v_lshl_add_u32 v16, v17, 3, v16
    v_bfe_u32 v17, v0, 4, 1
    v_lshl_add_u32 v16, v17, 2, v16
    v_bfe_u32 v17, v0, 5, 1
    v_lshl_add_u32 v16, v17, 4, v16
    v_lshlrev_b32 v16, 5, v16
    v_and_b32 v17, 3, v0
    v_lshl_add_u32 v16, v17, 3, v16
    s_mul_i32 s4, s9, 14336
    s_add_u32 s4, s4, 63488
    v_add_u32 v16, s4, v16
    ds_read_b64_tr_b16 v[192:193], v16 offset:0
    ds_read_b64_tr_b16 v[194:195], v16 offset:64
    ds_read_b64_tr_b16 v[196:197], v16 offset:1024
    ds_read_b64_tr_b16 v[198:199], v16 offset:1088
    ds_read_b64_tr_b16 v[200:201], v16 offset:2048
    ds_read_b64_tr_b16 v[202:203], v16 offset:2112
    ds_read_b64_tr_b16 v[204:205], v16 offset:3072
    ds_read_b64_tr_b16 v[206:207], v16 offset:3136
    ds_read_b64_tr_b16 v[208:209], v16 offset:4096
    ds_read_b64_tr_b16 v[210:211], v16 offset:4160
    ds_read_b64_tr_b16 v[212:213], v16 offset:5120
    ds_read_b64_tr_b16 v[214:215], v16 offset:5184
    ds_read_b64_tr_b16 v[216:217], v16 offset:6144
    ds_read_b64_tr_b16 v[218:219], v16 offset:6208
    ds_read_b64_tr_b16 v[220:221], v16 offset:7168
    ds_read_b64_tr_b16 v[222:223], v16 offset:7232
    ds_read_b64_tr_b16 v[224:225], v16 offset:8192
    ds_read_b64_tr_b16 v[226:227], v16 offset:8256
    ds_read_b64_tr_b16 v[228:229], v16 offset:9216
    ds_read_b64_tr_b16 v[230:231], v16 offset:9280
    ds_read_b64_tr_b16 v[232:233], v16 offset:10240
    ds_read_b64_tr_b16 v[234:235], v16 offset:10304
    ds_read_b64_tr_b16 v[236:237], v16 offset:11264
    ds_read_b64_tr_b16 v[238:239], v16 offset:11328
    ds_read_b64_tr_b16 v[240:241], v16 offset:12288
    ds_read_b64_tr_b16 v[242:243], v16 offset:12352
    ds_read_b64_tr_b16 v[244:245], v16 offset:13312
    ds_read_b64_tr_b16 v[246:247], v16 offset:13376
    v_bfe_u32 v12, v0, 1, 3
    v_lshrrev_b32 v17, 4, v0
    v_lshl_add_u32 v12, v12, 2, v17
    v_and_b32 v17, 1, v0
    v_lshl_add_u32 v12, v12, 1, v17
    v_lshlrev_b32 v12, 0, v12
    v_min_u32 v12, 55, v12
    v_lshlrev_b32 v12, 4, v12
    v_and_b32 v13, 15, v0
    v_lshlrev_b32 v13, 6, v13
    v_lshrrev_b32 v17, 4, v0
    v_lshl_add_u32 v13, v17, 2, v13
    s_lshl_b32 s4, s9, 4
    v_add_u32 v13, s4, v13
    v_mov_b32 v32, 0
    v_mov_b32 v33, 0
    v_mov_b32 v34, 0
    v_mov_b32 v35, 0
    v_mov_b32 v36, 0
    v_mov_b32 v37, 0
    v_mov_b32 v38, 0
    v_mov_b32 v39, 0
    v_mov_b32 v40, 0
    v_mov_b32 v41, 0
    v_mov_b32 v42, 0
    v_mov_b32 v43, 0
    v_mov_b32 v44, 0
    v_mov_b32 v45, 0
    v_mov_b32 v46, 0
    v_mov_b32 v47, 0
    v_mov_b32 v48, 0
    v_mov_b32 v49, 0
    v_mov_b32 v50, 0
    v_mov_b32 v51, 0
    v_mov_b32 v52, 0
    v_mov_b32 v53, 0
    v_mov_b32 v54, 0
    v_mov_b32 v55, 0
    v_mov_b32 v56, 0
    v_mov_b32 v57, 0
    v_mov_b32 v58, 0
    v_mov_b32 v59, 0
    v_mov_b32 v15, 0
    s_waitcnt lgkmcnt(0)
    s_add_u32 s4, s15, 1
    v_mov_b32 v16, 0
L_lw_155:
    s_sub_u32 s14, s14, 1
    s_cbranch_scc1 L_end_1
    s_sleep 1
    ds_read_b32 v17, v16 offset:10600
    s_waitcnt lgkmcnt(0)
    v_cmp_ne_u32 vcc, s4, v17
    s_cbranch_vccnz L_lw_155
    s_lshl_b32 s4, s15, 14
    s_mul_i32 s5, s9, 896
    s_add_u32 s4, s4, s5
    s_add_u32 s4, s4, 0x24c000
    s_mov_b64 vcc, -1
L_p3_156:
    s_sub_u32 s14, s14, 1
    s_cbranch_scc1 L_end_1
    s_sleep 14
    s_mov_b64 exec, vcc
    buffer_load_dwordx4 v[28:31], v12, s[44:47], s4 offen sc1
    s_waitcnt vmcnt(0)
    v_max3_u32 v14, v28, v29, v30
    v_max_u32 v14, v31, v14
    v_cmp_eq_u32 vcc, -1, v14
    s_cbranch_vccnz L_p3_156
    s_mov_b64 exec, -1
    s_nop 0
    v_smfmac_f32_16x16x64_bf16 v[32:35], v[28:31], v[192:199], v2
    v_smfmac_f32_16x16x64_bf16 v[36:39], v[28:31], v[200:207], v2
    v_smfmac_f32_16x16x64_bf16 v[40:43], v[28:31], v[208:215], v2
    v_smfmac_f32_16x16x64_bf16 v[44:47], v[28:31], v[216:223], v2
    v_smfmac_f32_16x16x64_bf16 v[48:51], v[28:31], v[224:231], v2
    v_smfmac_f32_16x16x64_bf16 v[52:55], v[28:31], v[232:239], v2
    v_smfmac_f32_16x16x64_bf16 v[56:59], v[28:31], v[240:247], v2
    s_nop 1
    v_add_f32_dpp v14, v32, v33 quad_perm:[0,1,2,3] row_mask:0x1 bank_mask:0xf
    v_add_f32_dpp v15, v38, v39 quad_perm:[0,1,2,3] row_mask:0x1 bank_mask:0xf
    v_add_f32_dpp v14, v40, v41 quad_perm:[0,1,2,3] row_mask:0x2 bank_mask:0xf
    v_add_f32_dpp v15, v46, v47 quad_perm:[0,1,2,3] row_mask:0x2 bank_mask:0xf
    v_add_f32_dpp v14, v48, v49 quad_perm:[0,1,2,3] row_mask:0x4 bank_mask:0xf
    v_add_f32_dpp v15, v54, v55 quad_perm:[0,1,2,3] row_mask:0x4 bank_mask:0xf
    v_add_f32_dpp v14, v56, v57 quad_perm:[0,1,2,3] row_mask:0x8 bank_mask:0xf
    v_add_f32 v14, v14, v15
    ds_write_b32 v13, v14 offset:10752
    s_mov_b64 exec, 1
    ds_add_u32 v10, v9 offset:10576
    s_mov_b64 exec, -1
L_tfix_150:
    s_cmp_lg_u32 s15, 0
    s_cbranch_scc1 L_fin_2
L_tb3_151:
    v_mov_b32 v16, 0
L_lw_163:
    s_sub_u32 s14, s14, 1
    s_cbranch_scc1 L_end_1
    s_sleep 2
    ds_read_b32 v17, v16 offset:10588
    s_waitcnt lgkmcnt(0)
    v_cmp_ne_u32 vcc, 8, v17
    s_cbranch_vccnz L_lw_163
    v_mov_b32 v16, -1.0
    ds_write_b32 v7, v16
    ds_write_b32 v7, v16 offset:9216
    v_mov_b32 v16, 0
L_lw_164:
    s_sub_u32 s14, s14, 1
    s_cbranch_scc1 L_end_1
    s_sleep 1
    ds_read_b32 v17, v16 offset:10572
    s_waitcnt lgkmcnt(0)
    v_cmp_eq_u32 vcc, 0, v17
    s_cbranch_vccnz L_lw_164
    v_readfirstlane_b32 s42, v17
    s_mov_b32 s15, 1
    s_mov_b32 s7, 0
    s_and_b32 s12, s42, 0x7ff
    s_sub_u32 s12, 2047, s12
    s_lshr_b32 s13, s12, 3
    s_cmp_eq_u32 s3, 4
    s_cselect_b32 s97, 1, 0
    s_cmp_lg_u32 s13, s2
    s_cbranch_scc1 L_hq_5
    s_mov_b32 s97, 0
    s_cmp_ge_u32 s3, 6
    s_cbranch_scc1 L_tq2_161
    s_waitcnt vmcnt(0)
    v_bfe_u32 v12, v0, 1, 3
    v_lshrrev_b32 v16, 4, v0
    v_lshl_add_u32 v12, v12, 2, v16
    v_and_b32 v16, 1, v0
    v_lshl_add_u32 v12, v12, 1, v16
    v_lshlrev_b32 v12, 6, v12
    v_mov_b32 v224, 0
    v_mov_b32 v225, 0
    v_mov_b32 v226, 0
    v_mov_b32 v227, 0
    v_mov_b32 v228, 0
    v_mov_b32 v229, 0
    v_mov_b32 v230, 0
    v_mov_b32 v231, 0
    v_mov_b32 v232, 0
    v_mov_b32 v233, 0
    v_mov_b32 v234, 0
    v_mov_b32 v235, 0
    v_mov_b32 v236, 0
    v_mov_b32 v237, 0
    v_mov_b32 v238, 0
    v_mov_b32 v239, 0
    v_mov_b32 v240, 0
    v_mov_b32 v241, 0
    v_mov_b32 v242, 0
    v_mov_b32 v243, 0
    v_mov_b32 v244, 0
    v_mov_b32 v245, 0
    v_mov_b32 v246, 0
    v_mov_b32 v247, 0
    v_mov_b32 v248, 0
    v_mov_b32 v249, 0
    v_mov_b32 v250, 0
    v_mov_b32 v251, 0
    v_mov_b32 v252, 0
    v_mov_b32 v253, 0
    v_mov_b32 v254, 0
    v_mov_b32 v255, 0
    v_mov_b32 v15, 0
    s_lshl_b32 s4, s9, 5
    v_lshlrev_b32 v13, 1, v0
    v_add_u32 v13, s4, v13
    v_mov_b32 v16, 0
L_lw_165:
    s_sub_u32 s14, s14, 1
    s_cbranch_scc1 L_end_1
    s_sleep 1
    ds_read_b32 v17, v16 offset:10584
    s_waitcnt lgkmcnt(0)
    v_cmp_eq_u32 vcc, 0, v17
    s_cbranch_vccnz L_lw_165
    s_cmp_eq_u32 s3, 4
    s_cselect_b32 s10, 0x3eb8aa3b, 1.0
    s_mov_b32 s4, 0x254000
    s_mov_b64 vcc, -1
L_p3_166:
    s_sub_u32 s14, s14, 1
    s_cbranch_scc1 L_end_1
    s_sleep 1
    s_mov_b64 exec, vcc
    buffer_load_dwordx4 v[28:31], v12, s[44:47], s4 offen sc1
    s_waitcnt vmcnt(0)
    v_max3_u32 v14, v28, v29, v30
    v_max_u32 v14, v31, v14
    v_cmp_eq_u32 vcc, -1, v14
    s_cbranch_vccnz L_p3_166
    s_mov_b64 exec, -1
    v_dot2_f32_bf16 v216, v28, s95, 0
    v_dot2_f32_bf16 v217, v28, v28, 0
    v_dot2_f32_bf16 v216, v29, s95, v216
    v_dot2_f32_bf16 v217, v29, v29, v217
    v_dot2_f32_bf16 v216, v30, s95, v216
    v_dot2_f32_bf16 v217, v30, v30, v217
    v_dot2_f32_bf16 v216, v31, s95, v216
    v_dot2_f32_bf16 v217, v31, v31, v217
    v_lshlrev_b32 v192, 16, v28
    v_and_b32 v193, 0xffff0000, v28
    v_lshlrev_b32 v194, 16, v29
    v_add_f32_dpp v216, v216, v216 quad_perm:[1,0,3,2] row_mask:0xf bank_mask:0xf
    v_add_f32_dpp v217, v217, v217 quad_perm:[1,0,3,2] row_mask:0xf bank_mask:0xf
    v_and_b32 v195, 0xffff0000, v29
    v_add_f32_dpp v216, v216, v216 quad_perm:[2,3,0,1] row_mask:0xf bank_mask:0xf
    v_add_f32_dpp v217, v217, v217 quad_perm:[2,3,0,1] row_mask:0xf bank_mask:0xf
    v_lshlrev_b32 v196, 16, v30
    v_add_f32_dpp v216, v216, v216 row_half_mirror row_mask:0xf bank_mask:0xf
    v_add_f32_dpp v217, v217, v217 row_half_mirror row_mask:0xf bank_mask:0xf
    v_and_b32 v197, 0xffff0000, v30
    v_add_f32_dpp v216, v216, v216 row_mirror row_mask:0xf bank_mask:0xf
    v_add_f32_dpp v217, v217, v217 row_mirror row_mask:0xf bank_mask:0xf
    v_lshlrev_b32 v198, 16, v31
    v_add_f32_dpp v216, v216, v216 row_bcast:15 row_mask:0xa bank_mask:0xf
    v_add_f32_dpp v217, v217, v217 row_bcast:15 row_mask:0xa bank_mask:0xf
    v_and_b32 v199, 0xffff0000, v31
    v_add_f32_dpp v216, v216, v216 row_bcast:31 row_mask:0xc bank_mask:0xf
    v_add_f32_dpp v217, v217, v217 row_bcast:31 row_mask:0xc bank_mask:0xf
    s_nop 0
    v_readlane_b32 s4, v216, 63
    v_readlane_b32 s5, v217, 63
    s_nop 1
    v_mov_b32 v213, 0x3b000000
    v_mul_f32 v214, s4, v213
    v_mul_f32 v212, s5, v213
    v_fma_f32 v212, -v214, v214, v212
    v_max_f32 v212, 0, v212
    v_cvt_pk_bf16_f32 v213, v214, v212
    v_and_b32 v212, 0xffff0000, v213
    v_add_f32 v212, 0x3727c5ac, v212
    v_cvt_pk_bf16_f32 v212, v212, v212
    v_lshlrev_b32 v212, 16, v212
    v_sqrt_f32 v212, v212
    v_lshlrev_b32 v214, 16, v213
    v_cvt_pk_bf16_f32 v212, v212, v212
    v_lshlrev_b32 v212, 16, v212
    v_rcp_f32 v212, v212
    v_sub_f32 v215, 0, v214
    v_mul_f32 v214, -v214, v212
    v_pk_add_f32 v[200:201], v[192:193], v[214:215] op_sel:[0,1] op_sel_hi:[1,1]
    v_pk_add_f32 v[202:203], v[194:195], v[214:215] op_sel:[0,1] op_sel_hi:[1,1]
    v_pk_add_f32 v[204:205], v[196:197], v[214:215] op_sel:[0,1] op_sel_hi:[1,1]
    v_pk_add_f32 v[206:207], v[198:199], v[214:215] op_sel:[0,1] op_sel_hi:[1,1]
    v_cvt_pk_bf16_f32 v208, v200, v201
    v_cvt_pk_bf16_f32 v209, v202, v203
    v_cvt_pk_bf16_f32 v210, v204, v205
    v_cvt_pk_bf16_f32 v211, v206, v207
    v_lshlrev_b32 v200, 16, v208
    v_and_b32 v201, 0xffff0000, v208
    v_lshlrev_b32 v202, 16, v209
    v_and_b32 v203, 0xffff0000, v209
    v_lshlrev_b32 v204, 16, v210
    v_and_b32 v205, 0xffff0000, v210
    v_lshlrev_b32 v206, 16, v211
    v_and_b32 v207, 0xffff0000, v211
    v_pk_mul_f32 v[200:201], v[200:201], v[212:213] op_sel_hi:[1,0]
    v_pk_mul_f32 v[202:203], v[202:203], v[212:213] op_sel_hi:[1,0]
    v_pk_mul_f32 v[204:205], v[204:205], v[212:213] op_sel_hi:[1,0]
    v_pk_mul_f32 v[206:207], v[206:207], v[212:213] op_sel_hi:[1,0]
    v_cvt_pk_bf16_f32 v208, v200, v201
    v_cvt_pk_bf16_f32 v209, v202, v203
    v_cvt_pk_bf16_f32 v210, v204, v205
    v_cvt_pk_bf16_f32 v211, v206, v207
    s_and_b32 s4, s12, 7
    s_mul_i32 s4, s4, 1056
    v_lshrrev_b32 v12, 2, v12
    v_add_u32 v12, s4, v12
    ds_write_b128 v12, v[208:211] offset:12288
    ds_write_b128 v12, v[28:31] offset:20736
    s_mov_b64 exec, 1
    ds_add_u32 v10, v9 offset:10604
    s_mov_b64 exec, -1
    ds_read_b128 v[32:35], v3 offset:0
    ds_read_b128 v[36:39], v3 offset:128
    ds_read_b128 v[40:43], v3 offset:256
    ds_read_b128 v[44:47], v3 offset:384
    ds_read_b128 v[48:51], v3 offset:512
    ds_read_b128 v[52:55], v3 offset:640
    ds_read_b128 v[56:59], v3 offset:768
    ds_read_b128 v[60:63], v3 offset:896
    v_smfmac_f32_16x16x64_bf16 v[224:227], v[208:211], v[64:71], v2
    v_smfmac_f32_16x16x64_bf16 v[228:231], v[208:211], v[72:79], v2
    v_smfmac_f32_16x16x64_bf16 v[232:235], v[208:211], v[80:87], v2
    v_smfmac_f32_16x16x64_bf16 v[236:239], v[208:211], v[88:95], v2
    v_smfmac_f32_16x16x64_bf16 v[240:243], v[208:211], v[96:103], v2
    v_smfmac_f32_16x16x64_bf16 v[244:247], v[208:211], v[104:111], v2
    v_smfmac_f32_16x16x64_bf16 v[248:251], v[208:211], v[112:119], v2
    v_smfmac_f32_16x16x64_bf16 v[252:255], v[208:211], v[120:127], v2
    s_nop 0
    v_add_f32_dpp v14, v224, v225 quad_perm:[0,1,2,3] row_mask:0x1 bank_mask:0xf
    v_add_f32_dpp v15, v230, v231 quad_perm:[0,1,2,3] row_mask:0x1 bank_mask:0xf
    v_add_f32_dpp v14, v232, v233 quad_perm:[0,1,2,3] row_mask:0x2 bank_mask:0xf
    v_add_f32_dpp v15, v238, v239 quad_perm:[0,1,2,3] row_mask:0x2 bank_mask:0xf
    v_add_f32_dpp v14, v240, v241 quad_perm:[0,1,2,3] row_mask:0x4 bank_mask:0xf
    v_add_f32_dpp v15, v246, v247 quad_perm:[0,1,2,3] row_mask:0x4 bank_mask:0xf
    v_add_f32_dpp v14, v248, v249 quad_perm:[0,1,2,3] row_mask:0x8 bank_mask:0xf
    v_add_f32_dpp v15, v254, v255 quad_perm:[0,1,2,3] row_mask:0x8 bank_mask:0xf
    v_add_f32 v14, v14, v15
    v_mov_b32 v15, v14
    s_nop 1
    v_permlane16_swap_b32 v14, v15
    v_add_f32 v14, v14, v15
    v_mov_b32 v15, v14
    s_nop 1
    v_permlane32_swap_b32 v14, v15
    v_add_f32 v14, v14, v15
    v_mul_f32 v192, s10, v14
    s_nop 1
    v_mov_b32_dpp v193, v192 quad_perm:[1,0,3,2] row_mask:0xf bank_mask:0xf
    v_cvt_pk_bf16_f32 v192, v192, v193
    v_min_u32 v192, -2, v192
    s_nop 1
    v_mov_b32_dpp v193, v192 row_shl:2 row_mask:0xf bank_mask:0xf
    v_mov_b32_dpp v194, v192 row_shl:4 row_mask:0xf bank_mask:0xf
    v_mov_b32_dpp v195, v192 row_shl:6 row_mask:0xf bank_mask:0xf
    v_lshlrev_b32 v12, 2, v13
    s_mov_b32 s4, 0x258000
    s_mov_b64 exec, 0x101
    buffer_store_dwordx4 v[192:195], v12, s[44:47], s4 offen sc1
    ds_write_b128 v13, v[192:195] offset:10624
    s_mov_b64 exec, -1
    s_mov_b64 exec, 1
    ds_add_u32 v10, v9 offset:10592
    s_mov_b64 exec, -1
    s_waitcnt lgkmcnt(0)
    v_mfma_f32_16x16x16_bf16 v[28:31], v[10:11], v[10:11], 0
    s_waitcnt vmcnt(1)
    s_nop 4
    v_smfmac_f32_16x16x64_bf16 v[28:31], v[32:35], v[128:135], v2
    v_smfmac_f32_16x16x64_bf16 v[28:31], v[36:39], v[136:143], v2
    v_smfmac_f32_16x16x64_bf16 v[28:31], v[40:43], v[144:151], v2
    v_smfmac_f32_16x16x64_bf16 v[28:31], v[44:47], v[152:159], v2
    v_smfmac_f32_16x16x64_bf16 v[28:31], v[48:51], v[160:167], v2
    v_smfmac_f32_16x16x64_bf16 v[28:31], v[52:55], v[168:175], v2
    v_smfmac_f32_16x16x64_bf16 v[28:31], v[56:59], v[176:183], v2
    v_smfmac_f32_16x16x64_bf16 v[28:31], v[60:63], v[184:191], v2
    s_nop 7
    v_add_f32 v28, v28, v29
    v_add_f32 v30, v30, v31
    v_cvt_pk_bf16_f32 v28, v28, v30
    ds_write_b16 v5, v28 offset:0
    ds_write_b16_d16_hi v5, v28 offset:16
    s_mov_b64 exec, 1
    ds_add_u32 v10, v9 offset:1024
    s_mov_b64 exec, -1
    s_branch L_htop_6
L_tq2_161:
    v_mov_b32 v16, 0
L_lw_168:
    s_sub_u32 s14, s14, 1
    s_cbranch_scc1 L_end_1
    ds_read_b32 v17, v16 offset:10604
    s_waitcnt lgkmcnt(0)
    v_cmp_eq_u32 vcc, 0, v17
    s_cbranch_vccnz L_lw_168
    s_branch L_hq_5
L_tw7_142:
    v_lshlrev_b32 v19, 6, v0
    s_lshl_b32 s4, s15, 14
    s_add_u32 s34, s4, 0x244000
    s_add_u32 s35, s34, 4096
    s_add_u32 s36, s34, 8192
    s_add_u32 s37, s34, 12288
    s_mov_b64 s[32:33], -1
    s_lshl_b32 s5, s43, 4
    s_add_u32 s4, s4, s5
    s_add_u32 s38, s4, 0x24c000
    s_lshl_b32 s13, s15, 2
    s_add_u32 s13, s13, 4
    s_mov_b32 s42, 0
    v_mov_b32 v16, 0
    v_lshlrev_b32 v17, 2, v0
    v_mul_u32_u24 v18, 1040, v0
    s_mov_b64 exec, 0xff
    ds_write_b32 v17, v16 offset:10496
    s_mov_b64 exec, 0x1ff
    ds_write_b32 v18, v16 offset:1024
    s_mov_b64 exec, -1
    s_cmp_lg_u32 s96, 0
    s_cbranch_scc1 L_kpoll_169x
    v_bfe_u32 v16, v0, 2, 1
    v_bfe_u32 v17, v0, 3, 1
    v_lshl_add_u32 v16, v17, 3, v16
    v_bfe_u32 v17, v0, 4, 1
    v_lshl_add_u32 v16, v17, 2, v16
    v_bfe_u32 v17, v0, 5, 1
    v_lshl_add_u32 v16, v17, 4, v16
    v_lshlrev_b32 v16, 4, v16
    v_and_b32 v17, 1, v0
    v_lshl_add_u32 v16, v17, 3, v16
    v_bfe_u32 v17, v0, 1, 1
    v_lshl_add_u32 v16, v17, 13, v16
    v_add_u32 v16, 63488, v16
    ds_read_b64_tr_b16 v[64:65], v16 offset:0
    ds_read_b64_tr_b16 v[66:67], v16 offset:32
    ds_read_b64_tr_b16 v[68:69], v16 offset:512
    ds_read_b64_tr_b16 v[70:71], v16 offset:544
    ds_read_b64_tr_b16 v[72:73], v16 offset:1024
    ds_read_b64_tr_b16 v[74:75], v16 offset:1056
    ds_read_b64_tr_b16 v[76:77], v16 offset:1536
    ds_read_b64_tr_b16 v[78:79], v16 offset:1568
    ds_read_b64_tr_b16 v[80:81], v16 offset:2048
    ds_read_b64_tr_b16 v[82:83], v16 offset:2080
    ds_read_b64_tr_b16 v[84:85], v16 offset:2560
    ds_read_b64_tr_b16 v[86:87], v16 offset:2592
    ds_read_b64_tr_b16 v[88:89], v16 offset:3072
    ds_read_b64_tr_b16 v[90:91], v16 offset:3104
    ds_read_b64_tr_b16 v[92:93], v16 offset:3584
    ds_read_b64_tr_b16 v[94:95], v16 offset:3616
    ds_read_b64_tr_b16 v[96:97], v16 offset:4096
    ds_read_b64_tr_b16 v[98:99], v16 offset:4128
    ds_read_b64_tr_b16 v[100:101], v16 offset:4608
    ds_read_b64_tr_b16 v[102:103], v16 offset:4640
    ds_read_b64_tr_b16 v[104:105], v16 offset:5120
    ds_read_b64_tr_b16 v[106:107], v16 offset:5152
    ds_read_b64_tr_b16 v[108:109], v16 offset:5632
    ds_read_b64_tr_b16 v[110:111], v16 offset:5664
    ds_read_b64_tr_b16 v[112:113], v16 offset:6144
    ds_read_b64_tr_b16 v[114:115], v16 offset:6176
    ds_read_b64_tr_b16 v[116:117], v16 offset:6656
    ds_read_b64_tr_b16 v[118:119], v16 offset:6688
    ds_read_b64_tr_b16 v[120:121], v16 offset:7168
    ds_read_b64_tr_b16 v[122:123], v16 offset:7200
    ds_read_b64_tr_b16 v[124:125], v16 offset:7680
    ds_read_b64_tr_b16 v[126:127], v16 offset:7712
    v_bfe_u32 v12, v0, 1, 3
    v_lshrrev_b32 v17, 4, v0
    v_lshl_add_u32 v12, v12, 2, v17
    v_and_b32 v17, 1, v0
    v_lshl_add_u32 v12, v12, 1, v17
    v_lshlrev_b32 v12, 4, v12
    s_branch L_kpoll_169f
L_kpoll_169x:
    v_bfe_u32 v16, v0, 2, 1
    v_bfe_u32 v17, v0, 3, 1
    v_lshl_add_u32 v16, v17, 3, v16
    v_bfe_u32 v17, v0, 4, 1
    v_lshl_add_u32 v16, v17, 2, v16
    v_bfe_u32 v17, v0, 5, 1
    v_lshl_add_u32 v16, v17, 4, v16
    v_lshlrev_b32 v16, 5, v16
    v_and_b32 v17, 3, v0
    v_lshl_add_u32 v16, v17, 3, v16
    s_mul_i32 s4, s9, 14336
    s_add_u32 s4, s4, 63488
    v_add_u32 v16, s4, v16
    ds_read_b64_tr_b16 v[192:193], v16 offset:0
    ds_read_b64_tr_b16 v[194:195], v16 offset:64
    ds_read_b64_tr_b16 v[196:197], v16 offset:1024
    ds_read_b64_tr_b16 v[198:199], v16 offset:1088
    ds_read_b64_tr_b16 v[200:201], v16 offset:2048
    ds_read_b64_tr_b16 v[202:203], v16 offset:2112
    ds_read_b64_tr_b16 v[204:205], v16 offset:3072
    ds_read_b64_tr_b16 v[206:207], v16 offset:3136
    ds_read_b64_tr_b16 v[208:209], v16 offset:4096
    ds_read_b64_tr_b16 v[210:211], v16 offset:4160
    ds_read_b64_tr_b16 v[212:213], v16 offset:5120
    ds_read_b64_tr_b16 v[214:215], v16 offset:5184
    ds_read_b64_tr_b16 v[216:217], v16 offset:6144
    ds_read_b64_tr_b16 v[218:219], v16 offset:6208
    ds_read_b64_tr_b16 v[220:221], v16 offset:7168
    ds_read_b64_tr_b16 v[222:223], v16 offset:7232
    ds_read_b64_tr_b16 v[224:225], v16 offset:8192
    ds_read_b64_tr_b16 v[226:227], v16 offset:8256
    ds_read_b64_tr_b16 v[228:229], v16 offset:9216
    ds_read_b64_tr_b16 v[230:231], v16 offset:9280
    ds_read_b64_tr_b16 v[232:233], v16 offset:10240
    ds_read_b64_tr_b16 v[234:235], v16 offset:10304
    ds_read_b64_tr_b16 v[236:237], v16 offset:11264
    ds_read_b64_tr_b16 v[238:239], v16 offset:11328
    ds_read_b64_tr_b16 v[240:241], v16 offset:12288
    ds_read_b64_tr_b16 v[242:243], v16 offset:12352
    ds_read_b64_tr_b16 v[244:245], v16 offset:13312
    ds_read_b64_tr_b16 v[246:247], v16 offset:13376
    v_bfe_u32 v12, v0, 1, 3
    v_lshrrev_b32 v17, 4, v0
    v_lshl_add_u32 v12, v12, 2, v17
    v_and_b32 v17, 1, v0
    v_lshl_add_u32 v12, v12, 1, v17
    v_lshlrev_b32 v12, 0, v12
    v_min_u32 v12, 55, v12
    v_lshlrev_b32 v12, 4, v12
    v_and_b32 v13, 15, v0
    v_lshlrev_b32 v13, 6, v13
    v_lshrrev_b32 v17, 4, v0
    v_lshl_add_u32 v13, v17, 2, v13
    s_lshl_b32 s4, s9, 4
    v_add_u32 v13, s4, v13
    v_mov_b32 v32, 0
    v_mov_b32 v33, 0
    v_mov_b32 v34, 0
    v_mov_b32 v35, 0
    v_mov_b32 v36, 0
    v_mov_b32 v37, 0
    v_mov_b32 v38, 0
    v_mov_b32 v39, 0
    v_mov_b32 v40, 0
    v_mov_b32 v41, 0
    v_mov_b32 v42, 0
    v_mov_b32 v43, 0
    v_mov_b32 v44, 0
    v_mov_b32 v45, 0
    v_mov_b32 v46, 0
    v_mov_b32 v47, 0
    v_mov_b32 v48, 0
    v_mov_b32 v49, 0
    v_mov_b32 v50, 0
    v_mov_b32 v51, 0
    v_mov_b32 v52, 0
    v_mov_b32 v53, 0
    v_mov_b32 v54, 0
    v_mov_b32 v55, 0
    v_mov_b32 v56, 0
    v_mov_b32 v57, 0
    v_mov_b32 v58, 0
    v_mov_b32 v59, 0
    v_mov_b32 v15, 0
    s_waitcnt lgkmcnt(0)
    v_and_b32 v69, 14, v0
    v_lshlrev_b32 v69, 1, v69
    v_and_b32 v73, 1, v0
    v_lshlrev_b32 v73, 4, v73
    v_sub_u32 v73, 16, v73
    v_and_b32 v74, 15, v0
    v_lshlrev_b32 v74, 6, v74
    v_lshlrev_b32 v75, 3, v0
L_kpoll_169f:
    v_mov_b32 v17, 0
L_lw_174:
    s_sub_u32 s14, s14, 1
    s_cbranch_scc1 L_end_1
    s_sleep 2
    ds_read_b32 v18, v17 offset:10596
    s_waitcnt lgkmcnt(0)
    v_cmp_ne_u32 vcc, s13, v18
    s_cbranch_vccnz L_lw_174
L_kpoll_169:
    s_sub_u32 s14, s14, 1
    s_cbranch_scc1 L_end_1
    s_mov_b64 exec, s[32:33]
    buffer_load_dword v20, v19, s[44:47], s34 offen sc1
    buffer_load_dword v21, v19, s[44:47], s35 offen sc1
    buffer_load_dword v22, v19, s[44:47], s36 offen sc1
    buffer_load_dword v23, v19, s[44:47], s37 offen sc1
L_kpoll_169y:
    s_waitcnt vmcnt(0)
    s_mov_b64 exec, -1
    v_max3_u32 v25, v20, v21, v22
    v_min3_u32 v24, v20, v21, v22
    v_max_u32 v25, v23, v25
    v_min_u32 v24, v23, v24
    v_cmp_lt_u32 vcc, s42, v25
    v_cmp_eq_u32 s[32:33], 0, v24
    s_cbranch_vccz L_same_175
    s_cmp_lg_u64 s[32:33], 0
    s_cbranch_scc1 L_kpoll_169
L_same_175s:
    v_max_u32_dpp v25, v25, v25 quad_perm:[1,0,3,2] row_mask:0xf bank_mask:0xf
    s_nop 1
    v_max_u32_dpp v25, v25, v25 quad_perm:[2,3,0,1] row_mask:0xf bank_mask:0xf
    s_nop 1
    v_max_u32_dpp v25, v25, v25 row_half_mirror row_mask:0xf bank_mask:0xf
    s_nop 1
    v_max_u32_dpp v25, v25, v25 row_mirror row_mask:0xf bank_mask:0xf
    s_nop 1
    v_max_u32_dpp v25, v25, v25 row_bcast:15 row_mask:0xa bank_mask:0xf
    s_nop 1
    v_max_u32_dpp v25, v25, v25 row_bcast:31 row_mask:0xc bank_mask:0xf
    s_nop 1
    v_readlane_b32 s42, v25, 63
    s_nop 1
    s_and_b32 s12, s42, 0x7ff
    s_sub_u32 s12, 2047, s12
    s_lshr_b32 s4, s12, 3
    s_lshl_b32 s4, s4, 10
    s_lshl_b32 s5, s15, 19
    s_add_u32 s4, s4, s5
    s_add_u32 s4, s4, 0x140000
    s_cmp_lg_u32 s96, 0
    s_cbranch_scc1 L_w7b_170
L_candr_176:
    buffer_load_dwordx4 v[24:27], v12, s[44:47], s4 offen sc1
    s_sub_u32 s14, s14, 1
    s_cbranch_scc1 L_end_1
    v_mov_b32 v32, 0
    v_mov_b32 v33, 0
    v_mov_b32 v34, 0
    v_mov_b32 v35, 0
    v_mov_b32 v36, 0
    v_mov_b32 v37, 0
    v_mov_b32 v38, 0
    v_mov_b32 v39, 0
    v_mov_b32 v40, 0
    v_mov_b32 v41, 0
    v_mov_b32 v42, 0
    v_mov_b32 v43, 0
    v_mov_b32 v44, 0
    v_mov_b32 v45, 0
    v_mov_b32 v46, 0
    v_mov_b32 v47, 0
    v_mov_b32 v48, 0
    v_mov_b32 v49, 0
    v_mov_b32 v50, 0
    v_mov_b32 v51, 0
    v_mov_b32 v52, 0
    v_mov_b32 v53, 0
    v_mov_b32 v54, 0
    v_mov_b32 v55, 0
    v_mov_b32 v56, 0
    v_mov_b32 v57, 0
    v_mov_b32 v58, 0
    v_mov_b32 v59, 0
    v_mov_b32 v60, 0
    v_mov_b32 v61, 0
    v_mov_b32 v62, 0
    v_mov_b32 v63, 0
    v_mov_b32 v15, 0
    s_waitcnt vmcnt(0) lgkmcnt(0)
    v_max3_u32 v18, v24, v25, v26
    v_max_u32 v18, v27, v18
    v_cmp_eq_u32 vcc, -1, v18
    s_cbranch_vccnz L_candr_176
    v_smfmac_f32_16x16x64_bf16 v[32:35], v[24:27], v[64:71], v2
    v_smfmac_f32_16x16x64_bf16 v[36:39], v[24:27], v[72:79], v2
    v_smfmac_f32_16x16x64_bf16 v[40:43], v[24:27], v[80:87], v2
    v_smfmac_f32_16x16x64_bf16 v[44:47], v[24:27], v[88:95], v2
    v_smfmac_f32_16x16x64_bf16 v[48:51], v[24:27], v[96:103], v2
    v_smfmac_f32_16x16x64_bf16 v[52:55], v[24:27], v[104:111], v2
    v_smfmac_f32_16x16x64_bf16 v[56:59], v[24:27], v[112:119], v2
    v_smfmac_f32_16x16x64_bf16 v[60:63], v[24:27], v[120:127], v2
    s_nop 0
    v_add_f32_dpp v14, v32, v33 quad_perm:[0,1,2,3] row_mask:0x1 bank_mask:0xf
    v_add_f32_dpp v15, v38, v39 quad_perm:[0,1,2,3] row_mask:0x1 bank_mask:0xf
    v_add_f32_dpp v14, v40, v41 quad_perm:[0,1,2,3] row_mask:0x2 bank_mask:0xf
    v_add_f32_dpp v15, v46, v47 quad_perm:[0,1,2,3] row_mask:0x2 bank_mask:0xf
    v_add_f32_dpp v14, v48, v49 quad_perm:[0,1,2,3] row_mask:0x4 bank_mask:0xf
    v_add_f32_dpp v15, v54, v55 quad_perm:[0,1,2,3] row_mask:0x4 bank_mask:0xf
    v_add_f32_dpp v14, v56, v57 quad_perm:[0,1,2,3] row_mask:0x8 bank_mask:0xf
    v_add_f32_dpp v15, v62, v63 quad_perm:[0,1,2,3] row_mask:0x8 bank_mask:0xf
    v_add_f32 v14, v14, v15
    v_mov_b32 v15, v14
    s_nop 1
    v_permlane16_swap_b32 v14, v15
    v_add_f32 v14, v14, v15
    v_mov_b32 v15, v14
    s_nop 1
    v_permlane32_swap_b32 v14, v15
    v_add_f32 v14, v14, v15
    v_cvt_pk_bf16_f32 v28, v14, v14
    v_lshlrev_b32 v28, 16, v28
    v_mul_f32 v30, 0xbfb8aa3b, v28
    v_exp_f32 v30, v30
    v_mov_b32_dpp v29, v28 row_ror:8 row_mask:0xf bank_mask:0xf
    v_add_f32 v30, 1.0, v30
    v_rcp_f32 v30, v30
    s_nop 0
    v_mul_f32 v30, v28, v30
    v_cvt_pk_bf16_f32 v30, v30, v30
    v_lshlrev_b32 v30, 16, v30
    v_mul_f32 v28, v30, v29
    s_nop 1
    v_mov_b32_dpp v29, v28 quad_perm:[1,0,3,2] row_mask:0xf bank_mask:0xf
    v_cvt_pk_bf16_f32 v28, v28, v29
    v_min_u32 v28, -2, v28
    s_nop 1
    v_mov_b32_dpp v29, v28 row_shl:2 row_mask:0xf bank_mask:0xf
    v_mov_b32_dpp v30, v28 row_shl:4 row_mask:0xf bank_mask:0xf
    v_mov_b32_dpp v31, v28 row_shl:6 row_mask:0xf bank_mask:0xf
    s_branch L_same_175
L_w7b_170:
    s_lshl_b32 s5, s43, 5
    s_add_u32 s4, s4, s5
    s_add_u32 s5, s4, 0x40000
L_w7b_170r:
    s_sub_u32 s14, s14, 1
    s_cbranch_scc1 L_end_1
    buffer_load_dword v71, v69, s[44:47], s4 offen sc1
    buffer_load_dword v72, v69, s[44:47], s5 offen sc1
    s_waitcnt vmcnt(0)
    v_max_u32 v70, v71, v72
    v_cmp_eq_u32 vcc, -1, v70
    s_cbranch_vccnz L_w7b_170r
    s_and_b32 s4, s42, 0xffff0000
    s_ashr_i32 s5, s4, 31
    s_not_b32 s5, s5
    s_or_b32 s5, s5, 0x80000000
    s_xor_b32 s4, s4, s5
    s_and_b32 s4, s4, 0xffff0000
    v_mov_b32 v70, s4
    v_mul_f32 v70, 0xbfb8aa3b, v70
    v_exp_f32 v70, v70
    v_lshlrev_b32 v71, v73, v71
    v_add_f32 v70, 1.0, v70
    v_rcp_f32 v70, v70
    v_lshlrev_b32 v72, v73, v72
    v_cvt_pk_bf16_f32 v70, v70, v70
    v_lshlrev_b32 v70, 16, v70
    v_and_b32 v71, 0xffff0000, v71
    v_and_b32 v72, 0xffff0000, v72
L_same_175:
    s_cmp_lg_u64 s[32:33], 0
    s_cbranch_scc1 L_kpoll_169
    s_cmp_lg_u32 s96, 0
    s_cbranch_scc1 L_w7e_173
    s_mov_b64 exec, 1
    buffer_store_dwordx4 v[28:31], off, s[44:47], s38 sc1
    s_mov_b64 exec, -1
L_w7e_173:
    v_mov_b32 v20, s42
    ds_write_b32 v10, v20 offset:10572
    s_mov_b64 exec, 1
    ds_add_u32 v10, v9 offset:10600
    s_mov_b64 exec, -1
    s_cmp_eq_u32 s15, 0
    s_cbranch_scc1 L_nodef_177
    s_lshr_b32 s4, s12, 3
    s_cmp_eq_u32 s4, s2
    s_cbranch_scc1 L_nodef_177
    v_mov_b32 v20, 0
L_lw_178:
    s_sub_u32 s14, s14, 1
    s_cbranch_scc1 L_end_1
    ds_read_b32 v21, v20 offset:10588
    s_waitcnt lgkmcnt(0)
    v_cmp_ne_u32 vcc, 12, v21
    s_cbranch_vccnz L_lw_178
    ds_read_b32 v20, v10 offset:10532
    s_waitcnt lgkmcnt(0)
    v_readfirstlane_b32 s4, v20
    s_and_b32 s4, s4, 0x7ff
    s_sub_u32 s4, 2047, s4
    s_and_b32 s5, s4, 7
    s_mul_i32 s5, s5, 1056
    v_add_u32 v20, s5, v1
    ds_read_b128 v[24:27], v20 offset:20736
    s_lshl_b32 s4, s4, 10
    s_waitcnt lgkmcnt(0)
    buffer_store_dwordx4 v[24:27], v1, s[52:55], s4 offen sc1
L_nodef_177:
    s_cmp_eq_u32 s96, 0
    s_cbranch_scc1 L_w7j_171
    s_lshl_b32 s10, s15, 2
    s_add_u32 s10, s10, 4
    s_lshl_b32 s4, s15, 14
    s_mul_i32 s5, s9, 896
    s_add_u32 s4, s4, s5
    s_add_u32 s4, s4, 0x24c000
    s_mov_b64 vcc, -1
L_p3_179:
    s_sub_u32 s14, s14, 1
    s_cbranch_scc1 L_end_1
    s_sleep 11
    s_mov_b64 exec, vcc
    buffer_load_dwordx4 v[28:31], v12, s[44:47], s4 offen sc1
    s_waitcnt vmcnt(0)
    v_max3_u32 v14, v28, v29, v30
    v_max_u32 v14, v31, v14
    v_cmp_eq_u32 vcc, -1, v14
    s_cbranch_vccnz L_p3_179
    s_mov_b64 exec, -1
    s_nop 0
    v_smfmac_f32_16x16x64_bf16 v[32:35], v[28:31], v[192:199], v2
    v_smfmac_f32_16x16x64_bf16 v[36:39], v[28:31], v[200:207], v2
    v_smfmac_f32_16x16x64_bf16 v[40:43], v[28:31], v[208:215], v2
    v_smfmac_f32_16x16x64_bf16 v[44:47], v[28:31], v[216:223], v2
    v_smfmac_f32_16x16x64_bf16 v[48:51], v[28:31], v[224:231], v2
    v_smfmac_f32_16x16x64_bf16 v[52:55], v[28:31], v[232:239], v2
    v_smfmac_f32_16x16x64_bf16 v[56:59], v[28:31], v[240:247], v2
    s_nop 1
    v_add_f32_dpp v14, v32, v33 quad_perm:[0,1,2,3] row_mask:0x1 bank_mask:0xf
    v_add_f32_dpp v15, v38, v39 quad_perm:[0,1,2,3] row_mask:0x1 bank_mask:0xf
    v_add_f32_dpp v14, v40, v41 quad_perm:[0,1,2,3] row_mask:0x2 bank_mask:0xf
    v_add_f32_dpp v15, v46, v47 quad_perm:[0,1,2,3] row_mask:0x2 bank_mask:0xf
    v_add_f32_dpp v14, v48, v49 quad_perm:[0,1,2,3] row_mask:0x4 bank_mask:0xf
    v_add_f32_dpp v15, v54, v55 quad_perm:[0,1,2,3] row_mask:0x4 bank_mask:0xf
    v_add_f32_dpp v14, v56, v57 quad_perm:[0,1,2,3] row_mask:0x8 bank_mask:0xf
    v_add_f32 v14, v14, v15
    ds_write_b32 v13, v14 offset:10752
    s_mov_b64 exec, 1
    ds_add_u32 v10, v9 offset:10576
    s_mov_b64 exec, -1
L_ppoll_172:
    s_sub_u32 s14, s14, 1
    s_cbranch_scc1 L_end_1
    ds_read_b32 v76, v10 offset:10576
    ds_read_b128 v[32:35], v74 offset:10752
    ds_read_b128 v[36:39], v74 offset:10768
    ds_read_b128 v[40:43], v74 offset:10784
    ds_read_b128 v[44:47], v74 offset:10800
    s_waitcnt lgkmcnt(0)
    v_cmp_ne_u32 vcc, s10, v76
    s_cbranch_vccnz L_ppoll_172
    v_pk_add_f32 v[32:33], v[32:33], v[40:41]
    v_pk_add_f32 v[34:35], v[34:35], v[42:43]
    v_pk_add_f32 v[36:37], v[36:37], v[44:45]
    v_pk_add_f32 v[38:39], v[38:39], v[46:47]
    v_pk_add_f32 v[32:33], v[32:33], v[34:35]
    v_pk_add_f32 v[36:37], v[36:37], v[38:39]
    v_pk_add_f32 v[32:33], v[32:33], v[36:37]
    v_add_f32 v32, v32, v33
    v_cvt_pk_bf16_f32 v32, v32, v32
    v_lshlrev_b32 v32, 16, v32
    v_mul_f32 v32, v32, v70
    v_cvt_pk_bf16_f32 v32, v32, v32
    v_lshlrev_b32 v32, 16, v32
    v_add_f32 v32, v32, v71
    v_cvt_pk_bf16_f32 v32, v32, v32
    v_lshlrev_b32 v32, 16, v32
    v_add_f32 v32, v32, v72
    s_nop 1
    v_mov_b32_dpp v33, v32 quad_perm:[1,0,3,2] row_mask:0xf bank_mask:0xf
    v_cvt_pk_bf16_f32 v32, v32, v33
    v_min_u32 v32, -2, v32
    s_nop 1
    v_mov_b32_dpp v33, v32 row_shl:2 row_mask:0xf bank_mask:0xf
    v_mov_b32_dpp v34, v32 row_shl:4 row_mask:0xf bank_mask:0xf
    v_mov_b32_dpp v35, v32 row_shl:6 row_mask:0xf bank_mask:0xf
    s_mov_b64 exec, 0x101
    s_cmp_lg_u32 s15, 0
    s_cbranch_scc1 L_yout_181
    s_lshl_b32 s4, s43, 7
    s_add_u32 s4, s4, 0x254000
    buffer_store_dwordx4 v[32:35], v75, s[44:47], s4 offen sc1
    s_mov_b64 exec, -1
    s_branch L_w7j_171
L_yout_181:
    s_lshl_b32 s4, s12, 10
    s_lshl_b32 s5, s43, 5
    s_add_u32 s4, s4, s5
    buffer_store_dwordx4 v[32:35], v69, s[52:55], s4 offen sc1
    s_mov_b64 exec, -1
L_w7j_171:
    ds_write_b32 v10, v9 offset:10584
    s_cmp_eq_u32 s15, 0
    s_cbranch_scc1 L_tb3_151
L_fin_2:
L_end_1:
    s_endpgm
L_slow_8:
    s_mov_b32 s7, 1
    s_waitcnt vmcnt(0) lgkmcnt(0)
    s_barrier
    s_cmp_ge_u32 s3, 4
    s_cbranch_scc1 L_hslow_182
    v_lshlrev_b32 v5, 4, v0
    v_lshlrev_b32 v4, 2, v0
    s_lshl_b32 s4, s3, 8
    s_add_u32 s4, s4, 12288
    v_add_u32 v3, s4, v4
    s_mov_b32 s12, 8
L_mx_183:
    ds_read_b128 v[8:11], v5
    v_mov_b32 v6, 0xff800000
    s_waitcnt lgkmcnt(0)
    v_mfma_f32_32x32x16_bf16 v[32:47], v[64:67], v[8:11], 0
    s_nop 15
    v_max3_f32 v6, v32, v33, v6
    v_max3_f32 v6, v34, v35, v6
    v_max3_f32 v6, v36, v37, v6
    v_max3_f32 v6, v38, v39, v6
    v_max3_f32 v6, v40, v41, v6
    v_max3_f32 v6, v42, v43, v6
    v_max3_f32 v6, v44, v45, v6
    v_max3_f32 v6, v46, v47, v6
    v_mfma_f32_32x32x16_bf16 v[32:47], v[68:71], v[8:11], 0
    s_nop 15
    v_max3_f32 v6, v32, v33, v6
    v_max3_f32 v6, v34, v35, v6
    v_max3_f32 v6, v36, v37, v6
    v_max3_f32 v6, v38, v39, v6
    v_max3_f32 v6, v40, v41, v6
    v_max3_f32 v6, v42, v43, v6
    v_max3_f32 v6, v44, v45, v6
    v_max3_f32 v6, v46, v47, v6
    v_mfma_f32_32x32x16_bf16 v[32:47], v[72:75], v[8:11], 0
    s_nop 15
    v_max3_f32 v6, v32, v33, v6
    v_max3_f32 v6, v34, v35, v6
    v_max3_f32 v6, v36, v37, v6
    v_max3_f32 v6, v38, v39, v6
    v_max3_f32 v6, v40, v41, v6
    v_max3_f32 v6, v42, v43, v6
    v_max3_f32 v6, v44, v45, v6
    v_max3_f32 v6, v46, v47, v6
    v_mfma_f32_32x32x16_bf16 v[32:47], v[76:79], v[8:11], 0
    s_nop 15
    v_max3_f32 v6, v32, v33, v6
    v_max3_f32 v6, v34, v35, v6
    v_max3_f32 v6, v36, v37, v6
    v_max3_f32 v6, v38, v39, v6
    v_max3_f32 v6, v40, v41, v6
    v_max3_f32 v6, v42, v43, v6
    v_max3_f32 v6, v44, v45, v6
    v_max3_f32 v6, v46, v47, v6
    v_mfma_f32_32x32x16_bf16 v[32:47], v[80:83], v[8:11], 0
    s_nop 15
    v_max3_f32 v6, v32, v33, v6
    v_max3_f32 v6, v34, v35, v6
    v_max3_f32 v6, v36, v37, v6
    v_max3_f32 v6, v38, v39, v6
    v_max3_f32 v6, v40, v41, v6
    v_max3_f32 v6, v42, v43, v6
    v_max3_f32 v6, v44, v45, v6
    v_max3_f32 v6, v46, v47, v6
    v_mfma_f32_32x32x16_bf16 v[32:47], v[84:87], v[8:11], 0
    s_nop 15
    v_max3_f32 v6, v32, v33, v6
    v_max3_f32 v6, v34, v35, v6
    v_max3_f32 v6, v36, v37, v6
    v_max3_f32 v6, v38, v39, v6
    v_max3_f32 v6, v40, v41, v6
    v_max3_f32 v6, v42, v43, v6
    v_max3_f32 v6, v44, v45, v6
    v_max3_f32 v6, v46, v47, v6
    v_mfma_f32_32x32x16_bf16 v[32:47], v[88:91], v[8:11], 0
    s_nop 15
    v_max3_f32 v6, v32, v33, v6
    v_max3_f32 v6, v34, v35, v6
    v_max3_f32 v6, v36, v37, v6
    v_max3_f32 v6, v38, v39, v6
    v_max3_f32 v6, v40, v41, v6
    v_max3_f32 v6, v42, v43, v6
    v_max3_f32 v6, v44, v45, v6
    v_max3_f32 v6, v46, v47, v6
    v_mfma_f32_32x32x16_bf16 v[32:47], v[92:95], v[8:11], 0
    s_nop 15
    v_max3_f32 v6, v32, v33, v6
    v_max3_f32 v6, v34, v35, v6
    v_max3_f32 v6, v36, v37, v6
    v_max3_f32 v6, v38, v39, v6
    v_max3_f32 v6, v40, v41, v6
    v_max3_f32 v6, v42, v43, v6
    v_max3_f32 v6, v44, v45, v6
    v_max3_f32 v6, v46, v47, v6
    v_mfma_f32_32x32x16_bf16 v[32:47], v[96:99], v[8:11], 0
    s_nop 15
    v_max3_f32 v6, v32, v33, v6
    v_max3_f32 v6, v34, v35, v6
    v_max3_f32 v6, v36, v37, v6
    v_max3_f32 v6, v38, v39, v6
    v_max3_f32 v6, v40, v41, v6
    v_max3_f32 v6, v42, v43, v6
    v_max3_f32 v6, v44, v45, v6
    v_max3_f32 v6, v46, v47, v6
    v_mfma_f32_32x32x16_bf16 v[32:47], v[100:103], v[8:11], 0
    s_nop 15
    v_max3_f32 v6, v32, v33, v6
    v_max3_f32 v6, v34, v35, v6
    v_max3_f32 v6, v36, v37, v6
    v_max3_f32 v6, v38, v39, v6
    v_max3_f32 v6, v40, v41, v6
    v_max3_f32 v6, v42, v43, v6
    v_max3_f32 v6, v44, v45, v6
    v_max3_f32 v6, v46, v47, v6
    v_mfma_f32_32x32x16_bf16 v[32:47], v[104:107], v[8:11], 0
    s_nop 15
    v_max3_f32 v6, v32, v33, v6
    v_max3_f32 v6, v34, v35, v6
    v_max3_f32 v6, v36, v37, v6
    v_max3_f32 v6, v38, v39, v6
    v_max3_f32 v6, v40, v41, v6
    v_max3_f32 v6, v42, v43, v6
    v_max3_f32 v6, v44, v45, v6
    v_max3_f32 v6, v46, v47, v6
    v_mfma_f32_32x32x16_bf16 v[32:47], v[108:111], v[8:11], 0
    s_nop 15
    v_max3_f32 v6, v32, v33, v6
    v_max3_f32 v6, v34, v35, v6
    v_max3_f32 v6, v36, v37, v6
    v_max3_f32 v6, v38, v39, v6
    v_max3_f32 v6, v40, v41, v6
    v_max3_f32 v6, v42, v43, v6
    v_max3_f32 v6, v44, v45, v6
    v_max3_f32 v6, v46, v47, v6
    v_mfma_f32_32x32x16_bf16 v[32:47], v[112:115], v[8:11], 0
    s_nop 15
    v_max3_f32 v6, v32, v33, v6
    v_max3_f32 v6, v34, v35, v6
    v_max3_f32 v6, v36, v37, v6
    v_max3_f32 v6, v38, v39, v6
    v_max3_f32 v6, v40, v41, v6
    v_max3_f32 v6, v42, v43, v6
    v_max3_f32 v6, v44, v45, v6
    v_max3_f32 v6, v46, v47, v6
    v_mfma_f32_32x32x16_bf16 v[32:47], v[116:119], v[8:11], 0
    s_nop 15
    v_max3_f32 v6, v32, v33, v6
    v_max3_f32 v6, v34, v35, v6
    v_max3_f32 v6, v36, v37, v6
    v_max3_f32 v6, v38, v39, v6
    v_max3_f32 v6, v40, v41, v6
    v_max3_f32 v6, v42, v43, v6
    v_max3_f32 v6, v44, v45, v6
    v_max3_f32 v6, v46, v47, v6
    v_mfma_f32_32x32x16_bf16 v[32:47], v[120:123], v[8:11], 0
    s_nop 15
    v_max3_f32 v6, v32, v33, v6
    v_max3_f32 v6, v34, v35, v6
    v_max3_f32 v6, v36, v37, v6
    v_max3_f32 v6, v38, v39, v6
    v_max3_f32 v6, v40, v41, v6
    v_max3_f32 v6, v42, v43, v6
    v_max3_f32 v6, v44, v45, v6
    v_max3_f32 v6, v46, v47, v6
    v_mfma_f32_32x32x16_bf16 v[32:47], v[124:127], v[8:11], 0
    s_nop 15
    v_max3_f32 v6, v32, v33, v6
    v_max3_f32 v6, v34, v35, v6
    v_max3_f32 v6, v36, v37, v6
    v_max3_f32 v6, v38, v39, v6
    v_max3_f32 v6, v40, v41, v6
    v_max3_f32 v6, v42, v43, v6
    v_max3_f32 v6, v44, v45, v6
    v_max3_f32 v6, v46, v47, v6
    ds_write_b32 v3, v6
    v_add_u32 v3, 1024, v3
    v_add_u32 v5, 1040, v5
    s_sub_u32 s12, s12, 1
    s_cmp_lg_u32 s12, 0
    s_cbranch_scc1 L_mx_183
    s_waitcnt lgkmcnt(0)
    s_barrier
    v_lshlrev_b32 v5, 4, v0
    s_mul_i32 s4, s3, 2304
    s_add_u32 m0, s4, 45056
    v_and_b32 v1, 31, v0
    v_lshlrev_b32 v1, 2, v1
    v_add_u32 v1, 12288, v1
    s_mov_b32 s10, 9216
    s_mov_b32 s11, -9216
    s_mov_b32 s12, 8
L_sl_184:
    ds_read_b128 v[8:11], v5
    ds_read_b32 v48, v1 offset:0
    ds_read_b32 v49, v1 offset:128
    ds_read_b32 v50, v1 offset:256
    ds_read_b32 v51, v1 offset:384
    ds_read_b32 v52, v1 offset:512
    ds_read_b32 v53, v1 offset:640
    ds_read_b32 v54, v1 offset:768
    ds_read_b32 v55, v1 offset:896
    v_mov_b32 v16, 0
    v_mov_b32 v17, 0
    v_mov_b32 v18, 0
    v_mov_b32 v19, 0
    v_mov_b32 v20, 0
    v_mov_b32 v21, 0
    v_mov_b32 v22, 0
    v_mov_b32 v23, 0
    v_mov_b32 v24, 0
    v_mov_b32 v25, 0
    v_mov_b32 v26, 0
    v_mov_b32 v27, 0
    v_mov_b32 v28, 0
    v_mov_b32 v29, 0
    v_mov_b32 v30, 0
    v_mov_b32 v31, 0
    s_waitcnt lgkmcnt(0)
    v_max3_f32 v6, v48, v49, v50
    v_max3_f32 v6, v51, v52, v6
    v_max3_f32 v6, v53, v54, v6
    v_max_f32 v6, v55, v6
    v_mfma_f32_32x32x16_bf16 v[32:47], v[64:67], v[8:11], 0
    s_nop 15
    v_sub_f32 v32, v32, v6
    v_sub_f32 v33, v33, v6
    v_sub_f32 v34, v34, v6
    v_sub_f32 v35, v35, v6
    v_sub_f32 v36, v36, v6
    v_sub_f32 v37, v37, v6
    v_sub_f32 v38, v38, v6
    v_sub_f32 v39, v39, v6
    v_sub_f32 v40, v40, v6
    v_sub_f32 v41, v41, v6
    v_sub_f32 v42, v42, v6
    v_sub_f32 v43, v43, v6
    v_sub_f32 v44, v44, v6
    v_sub_f32 v45, v45, v6
    v_sub_f32 v46, v46, v6
    v_sub_f32 v47, v47, v6
    v_exp_f32 v32, v32
    v_exp_f32 v33, v33
    v_exp_f32 v34, v34
    v_exp_f32 v35, v35
    v_exp_f32 v36, v36
    v_exp_f32 v37, v37
    v_exp_f32 v38, v38
    v_exp_f32 v39, v39
    v_exp_f32 v40, v40
    v_exp_f32 v41, v41
    v_exp_f32 v42, v42
    v_exp_f32 v43, v43
    v_exp_f32 v44, v44
    v_exp_f32 v45, v45
    v_exp_f32 v46, v46
    v_exp_f32 v47, v47
    s_nop 1
    v_smfmac_f32_32x32x32_bf16 v[16:31], v[128:131], v[32:39], v2
    v_smfmac_f32_32x32x32_bf16 v[16:31], v[132:135], v[40:47], v2
    v_mfma_f32_32x32x16_bf16 v[32:47], v[68:71], v[8:11], 0
    s_nop 15
    v_sub_f32 v32, v32, v6
    v_sub_f32 v33, v33, v6
    v_sub_f32 v34, v34, v6
    v_sub_f32 v35, v35, v6
    v_sub_f32 v36, v36, v6
    v_sub_f32 v37, v37, v6
    v_sub_f32 v38, v38, v6
    v_sub_f32 v39, v39, v6
    v_sub_f32 v40, v40, v6
    v_sub_f32 v41, v41, v6
    v_sub_f32 v42, v42, v6
    v_sub_f32 v43, v43, v6
    v_sub_f32 v44, v44, v6
    v_sub_f32 v45, v45, v6
    v_sub_f32 v46, v46, v6
    v_sub_f32 v47, v47, v6
    v_exp_f32 v32, v32
    v_exp_f32 v33, v33
    v_exp_f32 v34, v34
    v_exp_f32 v35, v35
    v_exp_f32 v36, v36
    v_exp_f32 v37, v37
    v_exp_f32 v38, v38
    v_exp_f32 v39, v39
    v_exp_f32 v40, v40
    v_exp_f32 v41, v41
    v_exp_f32 v42, v42
    v_exp_f32 v43, v43
    v_exp_f32 v44, v44
    v_exp_f32 v45, v45
    v_exp_f32 v46, v46
    v_exp_f32 v47, v47
    s_nop 1
    v_smfmac_f32_32x32x32_bf16 v[16:31], v[136:139], v[32:39], v2
    v_smfmac_f32_32x32x32_bf16 v[16:31], v[140:143], v[40:47], v2
    v_mfma_f32_32x32x16_bf16 v[32:47], v[72:75], v[8:11], 0
    s_nop 15
    v_sub_f32 v32, v32, v6
    v_sub_f32 v33, v33, v6
    v_sub_f32 v34, v34, v6
    v_sub_f32 v35, v35, v6
    v_sub_f32 v36, v36, v6
    v_sub_f32 v37, v37, v6
    v_sub_f32 v38, v38, v6
    v_sub_f32 v39, v39, v6
    v_sub_f32 v40, v40, v6
    v_sub_f32 v41, v41, v6
    v_sub_f32 v42, v42, v6
    v_sub_f32 v43, v43, v6
    v_sub_f32 v44, v44, v6
    v_sub_f32 v45, v45, v6
    v_sub_f32 v46, v46, v6
    v_sub_f32 v47, v47, v6
    v_exp_f32 v32, v32
    v_exp_f32 v33, v33
    v_exp_f32 v34, v34
    v_exp_f32 v35, v35
    v_exp_f32 v36, v36
    v_exp_f32 v37, v37
    v_exp_f32 v38, v38
    v_exp_f32 v39, v39
    v_exp_f32 v40, v40
    v_exp_f32 v41, v41
    v_exp_f32 v42, v42
    v_exp_f32 v43, v43
    v_exp_f32 v44, v44
    v_exp_f32 v45, v45
    v_exp_f32 v46, v46
    v_exp_f32 v47, v47
    s_nop 1
    v_smfmac_f32_32x32x32_bf16 v[16:31], v[144:147], v[32:39], v2
    v_smfmac_f32_32x32x32_bf16 v[16:31], v[148:151], v[40:47], v2
    v_mfma_f32_32x32x16_bf16 v[32:47], v[76:79], v[8:11], 0
    s_nop 15
    v_sub_f32 v32, v32, v6
    v_sub_f32 v33, v33, v6
    v_sub_f32 v34, v34, v6
    v_sub_f32 v35, v35, v6
    v_sub_f32 v36, v36, v6
    v_sub_f32 v37, v37, v6
    v_sub_f32 v38, v38, v6
    v_sub_f32 v39, v39, v6
    v_sub_f32 v40, v40, v6
    v_sub_f32 v41, v41, v6
    v_sub_f32 v42, v42, v6
    v_sub_f32 v43, v43, v6
    v_sub_f32 v44, v44, v6
    v_sub_f32 v45, v45, v6
    v_sub_f32 v46, v46, v6
    v_sub_f32 v47, v47, v6
    v_exp_f32 v32, v32
    v_exp_f32 v33, v33
    v_exp_f32 v34, v34
    v_exp_f32 v35, v35
    v_exp_f32 v36, v36
    v_exp_f32 v37, v37
    v_exp_f32 v38, v38
    v_exp_f32 v39, v39
    v_exp_f32 v40, v40
    v_exp_f32 v41, v41
    v_exp_f32 v42, v42
    v_exp_f32 v43, v43
    v_exp_f32 v44, v44
    v_exp_f32 v45, v45
    v_exp_f32 v46, v46
    v_exp_f32 v47, v47
    s_nop 1
    v_smfmac_f32_32x32x32_bf16 v[16:31], v[152:155], v[32:39], v2
    v_smfmac_f32_32x32x32_bf16 v[16:31], v[156:159], v[40:47], v2
    v_mfma_f32_32x32x16_bf16 v[32:47], v[80:83], v[8:11], 0
    s_nop 15
    v_sub_f32 v32, v32, v6
    v_sub_f32 v33, v33, v6
    v_sub_f32 v34, v34, v6
    v_sub_f32 v35, v35, v6
    v_sub_f32 v36, v36, v6
    v_sub_f32 v37, v37, v6
    v_sub_f32 v38, v38, v6
    v_sub_f32 v39, v39, v6
    v_sub_f32 v40, v40, v6
    v_sub_f32 v41, v41, v6
    v_sub_f32 v42, v42, v6
    v_sub_f32 v43, v43, v6
    v_sub_f32 v44, v44, v6
    v_sub_f32 v45, v45, v6
    v_sub_f32 v46, v46, v6
    v_sub_f32 v47, v47, v6
    v_exp_f32 v32, v32
    v_exp_f32 v33, v33
    v_exp_f32 v34, v34
    v_exp_f32 v35, v35
    v_exp_f32 v36, v36
    v_exp_f32 v37, v37
    v_exp_f32 v38, v38
    v_exp_f32 v39, v39
    v_exp_f32 v40, v40
    v_exp_f32 v41, v41
    v_exp_f32 v42, v42
    v_exp_f32 v43, v43
    v_exp_f32 v44, v44
    v_exp_f32 v45, v45
    v_exp_f32 v46, v46
    v_exp_f32 v47, v47
    s_nop 1
    v_smfmac_f32_32x32x32_bf16 v[16:31], v[160:163], v[32:39], v2
    v_smfmac_f32_32x32x32_bf16 v[16:31], v[164:167], v[40:47], v2
    v_mfma_f32_32x32x16_bf16 v[32:47], v[84:87], v[8:11], 0
    s_nop 15
    v_sub_f32 v32, v32, v6
    v_sub_f32 v33, v33, v6
    v_sub_f32 v34, v34, v6
    v_sub_f32 v35, v35, v6
    v_sub_f32 v36, v36, v6
    v_sub_f32 v37, v37, v6
    v_sub_f32 v38, v38, v6
    v_sub_f32 v39, v39, v6
    v_sub_f32 v40, v40, v6
    v_sub_f32 v41, v41, v6
    v_sub_f32 v42, v42, v6
    v_sub_f32 v43, v43, v6
    v_sub_f32 v44, v44, v6
    v_sub_f32 v45, v45, v6
    v_sub_f32 v46, v46, v6
    v_sub_f32 v47, v47, v6
    v_exp_f32 v32, v32
    v_exp_f32 v33, v33
    v_exp_f32 v34, v34
    v_exp_f32 v35, v35
    v_exp_f32 v36, v36
    v_exp_f32 v37, v37
    v_exp_f32 v38, v38
    v_exp_f32 v39, v39
    v_exp_f32 v40, v40
    v_exp_f32 v41, v41
    v_exp_f32 v42, v42
    v_exp_f32 v43, v43
    v_exp_f32 v44, v44
    v_exp_f32 v45, v45
    v_exp_f32 v46, v46
    v_exp_f32 v47, v47
    s_nop 1
    v_smfmac_f32_32x32x32_bf16 v[16:31], v[168:171], v[32:39], v2
    v_smfmac_f32_32x32x32_bf16 v[16:31], v[172:175], v[40:47], v2
    v_mfma_f32_32x32x16_bf16 v[32:47], v[88:91], v[8:11], 0
    s_nop 15
    v_sub_f32 v32, v32, v6
    v_sub_f32 v33, v33, v6
    v_sub_f32 v34, v34, v6
    v_sub_f32 v35, v35, v6
    v_sub_f32 v36, v36, v6
    v_sub_f32 v37, v37, v6
    v_sub_f32 v38, v38, v6
    v_sub_f32 v39, v39, v6
    v_sub_f32 v40, v40, v6
    v_sub_f32 v41, v41, v6
    v_sub_f32 v42, v42, v6
    v_sub_f32 v43, v43, v6
    v_sub_f32 v44, v44, v6
    v_sub_f32 v45, v45, v6
    v_sub_f32 v46, v46, v6
    v_sub_f32 v47, v47, v6
    v_exp_f32 v32, v32
    v_exp_f32 v33, v33
    v_exp_f32 v34, v34
    v_exp_f32 v35, v35
    v_exp_f32 v36, v36
    v_exp_f32 v37, v37
    v_exp_f32 v38, v38
    v_exp_f32 v39, v39
    v_exp_f32 v40, v40
    v_exp_f32 v41, v41
    v_exp_f32 v42, v42
    v_exp_f32 v43, v43
    v_exp_f32 v44, v44
    v_exp_f32 v45, v45
    v_exp_f32 v46, v46
    v_exp_f32 v47, v47
    s_nop 1
    v_smfmac_f32_32x32x32_bf16 v[16:31], v[176:179], v[32:39], v2
    v_smfmac_f32_32x32x32_bf16 v[16:31], v[180:183], v[40:47], v2
    v_mfma_f32_32x32x16_bf16 v[32:47], v[92:95], v[8:11], 0
    s_nop 15
    v_sub_f32 v32, v32, v6
    v_sub_f32 v33, v33, v6
    v_sub_f32 v34, v34, v6
    v_sub_f32 v35, v35, v6
    v_sub_f32 v36, v36, v6
    v_sub_f32 v37, v37, v6
    v_sub_f32 v38, v38, v6
    v_sub_f32 v39, v39, v6
    v_sub_f32 v40, v40, v6
    v_sub_f32 v41, v41, v6
    v_sub_f32 v42, v42, v6
    v_sub_f32 v43, v43, v6
    v_sub_f32 v44, v44, v6
    v_sub_f32 v45, v45, v6
    v_sub_f32 v46, v46, v6
    v_sub_f32 v47, v47, v6
    v_exp_f32 v32, v32
    v_exp_f32 v33, v33
    v_exp_f32 v34, v34
    v_exp_f32 v35, v35
    v_exp_f32 v36, v36
    v_exp_f32 v37, v37
    v_exp_f32 v38, v38
    v_exp_f32 v39, v39
    v_exp_f32 v40, v40
    v_exp_f32 v41, v41
    v_exp_f32 v42, v42
    v_exp_f32 v43, v43
    v_exp_f32 v44, v44
    v_exp_f32 v45, v45
    v_exp_f32 v46, v46
    v_exp_f32 v47, v47
    s_nop 1
    v_smfmac_f32_32x32x32_bf16 v[16:31], v[184:187], v[32:39], v2
    v_smfmac_f32_32x32x32_bf16 v[16:31], v[188:191], v[40:47], v2
    v_mfma_f32_32x32x16_bf16 v[32:47], v[96:99], v[8:11], 0
    s_nop 15
    v_sub_f32 v32, v32, v6
    v_sub_f32 v33, v33, v6
    v_sub_f32 v34, v34, v6
    v_sub_f32 v35, v35, v6
    v_sub_f32 v36, v36, v6
    v_sub_f32 v37, v37, v6
    v_sub_f32 v38, v38, v6
    v_sub_f32 v39, v39, v6
    v_sub_f32 v40, v40, v6
    v_sub_f32 v41, v41, v6
    v_sub_f32 v42, v42, v6
    v_sub_f32 v43, v43, v6
    v_sub_f32 v44, v44, v6
    v_sub_f32 v45, v45, v6
    v_sub_f32 v46, v46, v6
    v_sub_f32 v47, v47, v6
    v_exp_f32 v32, v32
    v_exp_f32 v33, v33
    v_exp_f32 v34, v34
    v_exp_f32 v35, v35
    v_exp_f32 v36, v36
    v_exp_f32 v37, v37
    v_exp_f32 v38, v38
    v_exp_f32 v39, v39
    v_exp_f32 v40, v40
    v_exp_f32 v41, v41
    v_exp_f32 v42, v42
    v_exp_f32 v43, v43
    v_exp_f32 v44, v44
    v_exp_f32 v45, v45
    v_exp_f32 v46, v46
    v_exp_f32 v47, v47
    s_nop 1
    v_smfmac_f32_32x32x32_bf16 v[16:31], v[192:195], v[32:39], v2
    v_smfmac_f32_32x32x32_bf16 v[16:31], v[196:199], v[40:47], v2
    v_mfma_f32_32x32x16_bf16 v[32:47], v[100:103], v[8:11], 0
    s_nop 15
    v_sub_f32 v32, v32, v6
    v_sub_f32 v33, v33, v6
    v_sub_f32 v34, v34, v6
    v_sub_f32 v35, v35, v6
    v_sub_f32 v36, v36, v6
    v_sub_f32 v37, v37, v6
    v_sub_f32 v38, v38, v6
    v_sub_f32 v39, v39, v6
    v_sub_f32 v40, v40, v6
    v_sub_f32 v41, v41, v6
    v_sub_f32 v42, v42, v6
    v_sub_f32 v43, v43, v6
    v_sub_f32 v44, v44, v6
    v_sub_f32 v45, v45, v6
    v_sub_f32 v46, v46, v6
    v_sub_f32 v47, v47, v6
    v_exp_f32 v32, v32
    v_exp_f32 v33, v33
    v_exp_f32 v34, v34
    v_exp_f32 v35, v35
    v_exp_f32 v36, v36
    v_exp_f32 v37, v37
    v_exp_f32 v38, v38
    v_exp_f32 v39, v39
    v_exp_f32 v40, v40
    v_exp_f32 v41, v41
    v_exp_f32 v42, v42
    v_exp_f32 v43, v43
    v_exp_f32 v44, v44
    v_exp_f32 v45, v45
    v_exp_f32 v46, v46
    v_exp_f32 v47, v47
    s_nop 1
    v_smfmac_f32_32x32x32_bf16 v[16:31], v[200:203], v[32:39], v2
    v_smfmac_f32_32x32x32_bf16 v[16:31], v[204:207], v[40:47], v2
    v_mfma_f32_32x32x16_bf16 v[32:47], v[104:107], v[8:11], 0
    s_nop 15
    v_sub_f32 v32, v32, v6
    v_sub_f32 v33, v33, v6
    v_sub_f32 v34, v34, v6
    v_sub_f32 v35, v35, v6
    v_sub_f32 v36, v36, v6
    v_sub_f32 v37, v37, v6
    v_sub_f32 v38, v38, v6
    v_sub_f32 v39, v39, v6
    v_sub_f32 v40, v40, v6
    v_sub_f32 v41, v41, v6
    v_sub_f32 v42, v42, v6
    v_sub_f32 v43, v43, v6
    v_sub_f32 v44, v44, v6
    v_sub_f32 v45, v45, v6
    v_sub_f32 v46, v46, v6
    v_sub_f32 v47, v47, v6
    v_exp_f32 v32, v32
    v_exp_f32 v33, v33
    v_exp_f32 v34, v34
    v_exp_f32 v35, v35
    v_exp_f32 v36, v36
    v_exp_f32 v37, v37
    v_exp_f32 v38, v38
    v_exp_f32 v39, v39
    v_exp_f32 v40, v40
    v_exp_f32 v41, v41
    v_exp_f32 v42, v42
    v_exp_f32 v43, v43
    v_exp_f32 v44, v44
    v_exp_f32 v45, v45
    v_exp_f32 v46, v46
    v_exp_f32 v47, v47
    s_nop 1
    v_smfmac_f32_32x32x32_bf16 v[16:31], v[208:211], v[32:39], v2
    v_smfmac_f32_32x32x32_bf16 v[16:31], v[212:215], v[40:47], v2
    v_mfma_f32_32x32x16_bf16 v[32:47], v[108:111], v[8:11], 0
    s_nop 15
    v_sub_f32 v32, v32, v6
    v_sub_f32 v33, v33, v6
    v_sub_f32 v34, v34, v6
    v_sub_f32 v35, v35, v6
    v_sub_f32 v36, v36, v6
    v_sub_f32 v37, v37, v6
    v_sub_f32 v38, v38, v6
    v_sub_f32 v39, v39, v6
    v_sub_f32 v40, v40, v6
    v_sub_f32 v41, v41, v6
    v_sub_f32 v42, v42, v6
    v_sub_f32 v43, v43, v6
    v_sub_f32 v44, v44, v6
    v_sub_f32 v45, v45, v6
    v_sub_f32 v46, v46, v6
    v_sub_f32 v47, v47, v6
    v_exp_f32 v32, v32
    v_exp_f32 v33, v33
    v_exp_f32 v34, v34
    v_exp_f32 v35, v35
    v_exp_f32 v36, v36
    v_exp_f32 v37, v37
    v_exp_f32 v38, v38
    v_exp_f32 v39, v39
    v_exp_f32 v40, v40
    v_exp_f32 v41, v41
    v_exp_f32 v42, v42
    v_exp_f32 v43, v43
    v_exp_f32 v44, v44
    v_exp_f32 v45, v45
    v_exp_f32 v46, v46
    v_exp_f32 v47, v47
    s_nop 1
    v_smfmac_f32_32x32x32_bf16 v[16:31], v[216:219], v[32:39], v2
    v_smfmac_f32_32x32x32_bf16 v[16:31], v[220:223], v[40:47], v2
    v_mfma_f32_32x32x16_bf16 v[32:47], v[112:115], v[8:11], 0
    s_nop 15
    v_sub_f32 v32, v32, v6
    v_sub_f32 v33, v33, v6
    v_sub_f32 v34, v34, v6
    v_sub_f32 v35, v35, v6
    v_sub_f32 v36, v36, v6
    v_sub_f32 v37, v37, v6
    v_sub_f32 v38, v38, v6
    v_sub_f32 v39, v39, v6
    v_sub_f32 v40, v40, v6
    v_sub_f32 v41, v41, v6
    v_sub_f32 v42, v42, v6
    v_sub_f32 v43, v43, v6
    v_sub_f32 v44, v44, v6
    v_sub_f32 v45, v45, v6
    v_sub_f32 v46, v46, v6
    v_sub_f32 v47, v47, v6
    v_exp_f32 v32, v32
    v_exp_f32 v33, v33
    v_exp_f32 v34, v34
    v_exp_f32 v35, v35
    v_exp_f32 v36, v36
    v_exp_f32 v37, v37
    v_exp_f32 v38, v38
    v_exp_f32 v39, v39
    v_exp_f32 v40, v40
    v_exp_f32 v41, v41
    v_exp_f32 v42, v42
    v_exp_f32 v43, v43
    v_exp_f32 v44, v44
    v_exp_f32 v45, v45
    v_exp_f32 v46, v46
    v_exp_f32 v47, v47
    s_nop 1
    v_smfmac_f32_32x32x32_bf16 v[16:31], v[224:227], v[32:39], v2
    v_smfmac_f32_32x32x32_bf16 v[16:31], v[228:231], v[40:47], v2
    v_mfma_f32_32x32x16_bf16 v[32:47], v[116:119], v[8:11], 0
    s_nop 15
    v_sub_f32 v32, v32, v6
    v_sub_f32 v33, v33, v6
    v_sub_f32 v34, v34, v6
    v_sub_f32 v35, v35, v6
    v_sub_f32 v36, v36, v6
    v_sub_f32 v37, v37, v6
    v_sub_f32 v38, v38, v6
    v_sub_f32 v39, v39, v6
    v_sub_f32 v40, v40, v6
    v_sub_f32 v41, v41, v6
    v_sub_f32 v42, v42, v6
    v_sub_f32 v43, v43, v6
    v_sub_f32 v44, v44, v6
    v_sub_f32 v45, v45, v6
    v_sub_f32 v46, v46, v6
    v_sub_f32 v47, v47, v6
    v_exp_f32 v32, v32
    v_exp_f32 v33, v33
    v_exp_f32 v34, v34
    v_exp_f32 v35, v35
    v_exp_f32 v36, v36
    v_exp_f32 v37, v37
    v_exp_f32 v38, v38
    v_exp_f32 v39, v39
    v_exp_f32 v40, v40
    v_exp_f32 v41, v41
    v_exp_f32 v42, v42
    v_exp_f32 v43, v43
    v_exp_f32 v44, v44
    v_exp_f32 v45, v45
    v_exp_f32 v46, v46
    v_exp_f32 v47, v47
    s_nop 1
    v_smfmac_f32_32x32x32_bf16 v[16:31], v[232:235], v[32:39], v2
    v_smfmac_f32_32x32x32_bf16 v[16:31], v[236:239], v[40:47], v2
    v_mfma_f32_32x32x16_bf16 v[32:47], v[120:123], v[8:11], 0
    s_nop 15
    v_sub_f32 v32, v32, v6
    v_sub_f32 v33, v33, v6
    v_sub_f32 v34, v34, v6
    v_sub_f32 v35, v35, v6
    v_sub_f32 v36, v36, v6
    v_sub_f32 v37, v37, v6
    v_sub_f32 v38, v38, v6
    v_sub_f32 v39, v39, v6
    v_sub_f32 v40, v40, v6
    v_sub_f32 v41, v41, v6
    v_sub_f32 v42, v42, v6
    v_sub_f32 v43, v43, v6
    v_sub_f32 v44, v44, v6
    v_sub_f32 v45, v45, v6
    v_sub_f32 v46, v46, v6
    v_sub_f32 v47, v47, v6
    v_exp_f32 v32, v32
    v_exp_f32 v33, v33
    v_exp_f32 v34, v34
    v_exp_f32 v35, v35
    v_exp_f32 v36, v36
    v_exp_f32 v37, v37
    v_exp_f32 v38, v38
    v_exp_f32 v39, v39
    v_exp_f32 v40, v40
    v_exp_f32 v41, v41
    v_exp_f32 v42, v42
    v_exp_f32 v43, v43
    v_exp_f32 v44, v44
    v_exp_f32 v45, v45
    v_exp_f32 v46, v46
    v_exp_f32 v47, v47
    s_nop 1
    v_smfmac_f32_32x32x32_bf16 v[16:31], v[240:243], v[32:39], v2
    v_smfmac_f32_32x32x32_bf16 v[16:31], v[244:247], v[40:47], v2
    v_mfma_f32_32x32x16_bf16 v[32:47], v[124:127], v[8:11], 0
    s_nop 15
    v_sub_f32 v32, v32, v6
    v_sub_f32 v33, v33, v6
    v_sub_f32 v34, v34, v6
    v_sub_f32 v35, v35, v6
    v_sub_f32 v36, v36, v6
    v_sub_f32 v37, v37, v6
    v_sub_f32 v38, v38, v6
    v_sub_f32 v39, v39, v6
    v_sub_f32 v40, v40, v6
    v_sub_f32 v41, v41, v6
    v_sub_f32 v42, v42, v6
    v_sub_f32 v43, v43, v6
    v_sub_f32 v44, v44, v6
    v_sub_f32 v45, v45, v6
    v_sub_f32 v46, v46, v6
    v_sub_f32 v47, v47, v6
    v_exp_f32 v32, v32
    v_exp_f32 v33, v33
    v_exp_f32 v34, v34
    v_exp_f32 v35, v35
    v_exp_f32 v36, v36
    v_exp_f32 v37, v37
    v_exp_f32 v38, v38
    v_exp_f32 v39, v39
    v_exp_f32 v40, v40
    v_exp_f32 v41, v41
    v_exp_f32 v42, v42
    v_exp_f32 v43, v43
    v_exp_f32 v44, v44
    v_exp_f32 v45, v45
    v_exp_f32 v46, v46
    v_exp_f32 v47, v47
    s_nop 1
    v_smfmac_f32_32x32x32_bf16 v[16:31], v[248:251], v[32:39], v2
    v_smfmac_f32_32x32x32_bf16 v[16:31], v[252:255], v[40:47], v2
    s_nop 15
    ds_write_addtid_b32 v16 offset:0
    ds_write_addtid_b32 v17 offset:256
    ds_write_addtid_b32 v18 offset:512
    ds_write_addtid_b32 v19 offset:768
    ds_write_addtid_b32 v20 offset:1024
    ds_write_addtid_b32 v21 offset:1280
    ds_write_addtid_b32 v22 offset:1536
    ds_write_addtid_b32 v23 offset:1792
    ds_write_addtid_b32 v24 offset:2048
    s_bitcmp0_b32 s12, 0
    s_cselect_b32 s4, s10, s11
    s_add_u32 m0, m0, s4
    v_add_u32 v5, 1040, v5
    v_add_u32 v1, 1024, v1
    s_waitcnt lgkmcnt(0)
    s_barrier
    s_sub_u32 s12, s12, 1
    s_cmp_lg_u32 s12, 0
    s_cbranch_scc1 L_sl_184
    s_branch L_epi_7
L_hslow_182:
    v_mov_b32 v16, -1.0
    ds_write_b32 v7, v16
    ds_write_b32 v7, v16 offset:9216
    v_mov_b32 v96, -1.0
    v_mov_b32 v20, 0
    v_lshlrev_b32 v21, 2, v0
    v_mul_u32_u24 v22, 1040, v0
    s_mov_b64 exec, 0xff
    ds_write_b32 v21, v20 offset:10496
    s_mov_b64 exec, -1
    v_mov_b32 v64, 0
    v_mov_b32 v65, 0
    v_mov_b32 v66, 0
    v_mov_b32 v67, 0
    v_mov_b32 v68, 0
    v_mov_b32 v69, 0
    v_mov_b32 v70, 0
    v_mov_b32 v71, 0
    v_mov_b32 v72, 0
    v_mov_b32 v73, 0
    v_mov_b32 v74, 0
    v_mov_b32 v75, 0
    v_mov_b32 v76, 0
    v_mov_b32 v77, 0
    v_mov_b32 v78, 0
    v_mov_b32 v79, 0
    v_mov_b32 v80, 0
    v_mov_b32 v81, 0
    v_mov_b32 v82, 0
    v_mov_b32 v83, 0
    v_mov_b32 v84, 0
    v_mov_b32 v85, 0
    v_mov_b32 v86, 0
    v_mov_b32 v87, 0
    v_mov_b32 v88, 0
    v_mov_b32 v89, 0
    v_mov_b32 v90, 0
    v_mov_b32 v91, 0
    v_mov_b32 v92, 0
    v_mov_b32 v93, 0
    v_mov_b32 v94, 0
    v_mov_b32 v95, 0
    s_waitcnt lgkmcnt(0)
    s_barrier
    s_add_u32 s4, s8, 0x80000
    buffer_load_dwordx4 v[192:195], v1, s[44:47], s4 offen offset:0 sc1
    buffer_load_dwordx4 v[196:199], v1, s[44:47], s4 offen offset:1024 sc1
    buffer_load_dwordx4 v[200:203], v1, s[44:47], s4 offen offset:2048 sc1
    buffer_load_dwordx4 v[204:207], v1, s[44:47], s4 offen offset:3072 sc1
    s_add_u32 s4, s4, 4096
    buffer_load_dwordx4 v[208:211], v1, s[44:47], s4 offen offset:0 sc1
    buffer_load_dwordx4 v[212:215], v1, s[44:47], s4 offen offset:1024 sc1
    buffer_load_dwordx4 v[216:219], v1, s[44:47], s4 offen offset:2048 sc1
    buffer_load_dwordx4 v[220:223], v1, s[44:47], s4 offen offset:3072 sc1
    s_add_u32 s4, s4, 4096
    buffer_load_dwordx4 v[224:227], v1, s[44:47], s4 offen offset:0 sc1
    buffer_load_dwordx4 v[228:231], v1, s[44:47], s4 offen offset:1024 sc1
    buffer_load_dwordx4 v[232:235], v1, s[44:47], s4 offen offset:2048 sc1
    buffer_load_dwordx4 v[236:239], v1, s[44:47], s4 offen offset:3072 sc1
    s_add_u32 s4, s4, 4096
    buffer_load_dwordx4 v[240:243], v1, s[44:47], s4 offen offset:0 sc1
    buffer_load_dwordx4 v[244:247], v1, s[44:47], s4 offen offset:1024 sc1
    buffer_load_dwordx4 v[248:251], v1, s[44:47], s4 offen offset:2048 sc1
    buffer_load_dwordx4 v[252:255], v1, s[44:47], s4 offen offset:3072 sc1
    s_waitcnt lgkmcnt(0)
    s_barrier
    s_branch L_npoll_185x
L_npoll_185:
    s_sub_u32 s14, s14, 1
    s_cbranch_scc1 L_end_1
    s_sleep 0
L_npoll_185x:
    ds_read_b32 v24, v7 offset:0
    s_waitcnt lgkmcnt(0)
    v_cmp_eq_f32 vcc, -1.0, v24
    s_cbranch_vccnz L_npoll_185
    ds_read2st64_b32 v[16:17], v6 offset0:0 offset1:1
    ds_read2st64_b32 v[18:19], v6 offset0:9 offset1:10
    ds_read2st64_b32 v[20:21], v6 offset0:18 offset1:19
    ds_read2st64_b32 v[22:23], v6 offset0:27 offset1:28
    ds_write_b32 v7, v96 offset:0
    v_add_f32_dpp v24, v24, v24 quad_perm:[1,0,3,2] row_mask:0xf bank_mask:0xf
    s_nop 1
    v_add_f32_dpp v24, v24, v24 quad_perm:[2,3,0,1] row_mask:0xf bank_mask:0xf
    s_nop 0
    v_rcp_f32 v25, v24
    s_waitcnt lgkmcnt(3)
    v_add_f32 v16, v16, v18
    v_add_f32 v17, v17, v19
    s_waitcnt lgkmcnt(1)
    v_add_f32 v20, v20, v22
    v_add_f32 v21, v21, v23
    v_add_f32 v16, v16, v20
    v_add_f32 v17, v17, v21
    v_maximum3_f32 v12, |v16|, |v17|, v12
    v_mul_f32 v16, v16, v25
    v_mul_f32 v17, v17, v25
    v_maximum3_f32 v13, v24, v25, v13
    v_cvt_pk_bf16_f32 v16, v16, v17
    ds_write_b32 v8, v16 offset:0
    s_mov_b64 exec, 1
    ds_add_u32 v10, v9 offset:10496
    s_mov_b64 exec, -1
L_opoll_186:
    s_sub_u32 s14, s14, 1
    s_cbranch_scc1 L_end_1
    ds_read_b32 v16, v10 offset:10496
    ds_read_b128 v[28:31], v4 offset:0
    s_waitcnt lgkmcnt(0)
    v_cmp_ne_u32 vcc, 4, v16
    s_cbranch_vccnz L_opoll_186
    s_waitcnt vmcnt(0)
    v_smfmac_f32_16x16x64_bf16 v[64:67], v[28:31], v[192:199], v2
    v_smfmac_f32_16x16x64_bf16 v[68:71], v[28:31], v[200:207], v2
    v_smfmac_f32_16x16x64_bf16 v[72:75], v[28:31], v[208:215], v2
    v_smfmac_f32_16x16x64_bf16 v[76:79], v[28:31], v[216:223], v2
    v_smfmac_f32_16x16x64_bf16 v[80:83], v[28:31], v[224:231], v2
    v_smfmac_f32_16x16x64_bf16 v[84:87], v[28:31], v[232:239], v2
    v_smfmac_f32_16x16x64_bf16 v[88:91], v[28:31], v[240:247], v2
    v_smfmac_f32_16x16x64_bf16 v[92:95], v[28:31], v[248:255], v2
    s_add_u32 s4, s8, 0x90000
    buffer_load_dwordx4 v[192:195], v1, s[44:47], s4 offen offset:0 sc1
    buffer_load_dwordx4 v[196:199], v1, s[44:47], s4 offen offset:1024 sc1
    buffer_load_dwordx4 v[200:203], v1, s[44:47], s4 offen offset:2048 sc1
    buffer_load_dwordx4 v[204:207], v1, s[44:47], s4 offen offset:3072 sc1
    s_add_u32 s4, s4, 4096
    buffer_load_dwordx4 v[208:211], v1, s[44:47], s4 offen offset:0 sc1
    buffer_load_dwordx4 v[212:215], v1, s[44:47], s4 offen offset:1024 sc1
    buffer_load_dwordx4 v[216:219], v1, s[44:47], s4 offen offset:2048 sc1
    buffer_load_dwordx4 v[220:223], v1, s[44:47], s4 offen offset:3072 sc1
    s_add_u32 s4, s4, 4096
    buffer_load_dwordx4 v[224:227], v1, s[44:47], s4 offen offset:0 sc1
    buffer_load_dwordx4 v[228:231], v1, s[44:47], s4 offen offset:1024 sc1
    buffer_load_dwordx4 v[232:235], v1, s[44:47], s4 offen offset:2048 sc1
    buffer_load_dwordx4 v[236:239], v1, s[44:47], s4 offen offset:3072 sc1
    s_add_u32 s4, s4, 4096
    buffer_load_dwordx4 v[240:243], v1, s[44:47], s4 offen offset:0 sc1
    buffer_load_dwordx4 v[244:247], v1, s[44:47], s4 offen offset:1024 sc1
    buffer_load_dwordx4 v[248:251], v1, s[44:47], s4 offen offset:2048 sc1
    buffer_load_dwordx4 v[252:255], v1, s[44:47], s4 offen offset:3072 sc1
    s_waitcnt lgkmcnt(0)
    s_barrier
    s_branch L_npoll_187x
L_npoll_187:
    s_sub_u32 s14, s14, 1
    s_cbranch_scc1 L_end_1
    s_sleep 0
L_npoll_187x:
    ds_read_b32 v24, v7 offset:9216
    s_waitcnt lgkmcnt(0)
    v_cmp_eq_f32 vcc, -1.0, v24
    s_cbranch_vccnz L_npoll_187
    ds_read2st64_b32 v[16:17], v6 offset0:36 offset1:37
    ds_read2st64_b32 v[18:19], v6 offset0:45 offset1:46
    ds_read2st64_b32 v[20:21], v6 offset0:54 offset1:55
    ds_read2st64_b32 v[22:23], v6 offset0:63 offset1:64
    ds_write_b32 v7, v96 offset:9216
    v_add_f32_dpp v24, v24, v24 quad_perm:[1,0,3,2] row_mask:0xf bank_mask:0xf
    s_nop 1
    v_add_f32_dpp v24, v24, v24 quad_perm:[2,3,0,1] row_mask:0xf bank_mask:0xf
    s_nop 0
    v_rcp_f32 v25, v24
    s_waitcnt lgkmcnt(3)
    v_add_f32 v16, v16, v18
    v_add_f32 v17, v17, v19
    s_waitcnt lgkmcnt(1)
    v_add_f32 v20, v20, v22
    v_add_f32 v21, v21, v23
    v_add_f32 v16, v16, v20
    v_add_f32 v17, v17, v21
    v_maximum3_f32 v12, |v16|, |v17|, v12
    v_mul_f32 v16, v16, v25
    v_mul_f32 v17, v17, v25
    v_maximum3_f32 v13, v24, v25, v13
    v_cvt_pk_bf16_f32 v16, v16, v17
    ds_write_b32 v8, v16 offset:128
    s_mov_b64 exec, 1
    ds_add_u32 v10, v9 offset:10500
    s_mov_b64 exec, -1
L_opoll_188:
    s_sub_u32 s14, s14, 1
    s_cbranch_scc1 L_end_1
    ds_read_b32 v16, v10 offset:10500
    ds_read_b128 v[28:31], v4 offset:128
    s_waitcnt lgkmcnt(0)
    v_cmp_ne_u32 vcc, 4, v16
    s_cbranch_vccnz L_opoll_188
    s_waitcnt vmcnt(0)
    v_smfmac_f32_16x16x64_bf16 v[64:67], v[28:31], v[192:199], v2
    v_smfmac_f32_16x16x64_bf16 v[68:71], v[28:31], v[200:207], v2
    v_smfmac_f32_16x16x64_bf16 v[72:75], v[28:31], v[208:215], v2
    v_smfmac_f32_16x16x64_bf16 v[76:79], v[28:31], v[216:223], v2
    v_smfmac_f32_16x16x64_bf16 v[80:83], v[28:31], v[224:231], v2
    v_smfmac_f32_16x16x64_bf16 v[84:87], v[28:31], v[232:239], v2
    v_smfmac_f32_16x16x64_bf16 v[88:91], v[28:31], v[240:247], v2
    v_smfmac_f32_16x16x64_bf16 v[92:95], v[28:31], v[248:255], v2
    s_add_u32 s4, s8, 0xa0000
    buffer_load_dwordx4 v[192:195], v1, s[44:47], s4 offen offset:0 sc1
    buffer_load_dwordx4 v[196:199], v1, s[44:47], s4 offen offset:1024 sc1
    buffer_load_dwordx4 v[200:203], v1, s[44:47], s4 offen offset:2048 sc1
    buffer_load_dwordx4 v[204:207], v1, s[44:47], s4 offen offset:3072 sc1
    s_add_u32 s4, s4, 4096
    buffer_load_dwordx4 v[208:211], v1, s[44:47], s4 offen offset:0 sc1
    buffer_load_dwordx4 v[212:215], v1, s[44:47], s4 offen offset:1024 sc1
    buffer_load_dwordx4 v[216:219], v1, s[44:47], s4 offen offset:2048 sc1
    buffer_load_dwordx4 v[220:223], v1, s[44:47], s4 offen offset:3072 sc1
    s_add_u32 s4, s4, 4096
    buffer_load_dwordx4 v[224:227], v1, s[44:47], s4 offen offset:0 sc1
    buffer_load_dwordx4 v[228:231], v1, s[44:47], s4 offen offset:1024 sc1
    buffer_load_dwordx4 v[232:235], v1, s[44:47], s4 offen offset:2048 sc1
    buffer_load_dwordx4 v[236:239], v1, s[44:47], s4 offen offset:3072 sc1
    s_add_u32 s4, s4, 4096
    buffer_load_dwordx4 v[240:243], v1, s[44:47], s4 offen offset:0 sc1
    buffer_load_dwordx4 v[244:247], v1, s[44:47], s4 offen offset:1024 sc1
    buffer_load_dwordx4 v[248:251], v1, s[44:47], s4 offen offset:2048 sc1
    buffer_load_dwordx4 v[252:255], v1, s[44:47], s4 offen offset:3072 sc1
    s_waitcnt lgkmcnt(0)
    s_barrier
    s_branch L_npoll_189x
L_npoll_189:
    s_sub_u32 s14, s14, 1
    s_cbranch_scc1 L_end_1
    s_sleep 0
L_npoll_189x:
    ds_read_b32 v24, v7 offset:0
    s_waitcnt lgkmcnt(0)
    v_cmp_eq_f32 vcc, -1.0, v24
    s_cbranch_vccnz L_npoll_189
    ds_read2st64_b32 v[16:17], v6 offset0:0 offset1:1
    ds_read2st64_b32 v[18:19], v6 offset0:9 offset1:10
    ds_read2st64_b32 v[20:21], v6 offset0:18 offset1:19
    ds_read2st64_b32 v[22:23], v6 offset0:27 offset1:28
    ds_write_b32 v7, v96 offset:0
    v_add_f32_dpp v24, v24, v24 quad_perm:[1,0,3,2] row_mask:0xf bank_mask:0xf
    s_nop 1
    v_add_f32_dpp v24, v24, v24 quad_perm:[2,3,0,1] row_mask:0xf bank_mask:0xf
    s_nop 0
    v_rcp_f32 v25, v24
    s_waitcnt lgkmcnt(3)
    v_add_f32 v16, v16, v18
    v_add_f32 v17, v17, v19
    s_waitcnt lgkmcnt(1)
    v_add_f32 v20, v20, v22
    v_add_f32 v21, v21, v23
    v_add_f32 v16, v16, v20
    v_add_f32 v17, v17, v21
    v_maximum3_f32 v12, |v16|, |v17|, v12
    v_mul_f32 v16, v16, v25
    v_mul_f32 v17, v17, v25
    v_maximum3_f32 v13, v24, v25, v13
    v_cvt_pk_bf16_f32 v16, v16, v17
    ds_write_b32 v8, v16 offset:256
    s_mov_b64 exec, 1
    ds_add_u32 v10, v9 offset:10504
    s_mov_b64 exec, -1
L_opoll_190:
    s_sub_u32 s14, s14, 1
    s_cbranch_scc1 L_end_1
    ds_read_b32 v16, v10 offset:10504
    ds_read_b128 v[28:31], v4 offset:256
    s_waitcnt lgkmcnt(0)
    v_cmp_ne_u32 vcc, 4, v16
    s_cbranch_vccnz L_opoll_190
    s_waitcnt vmcnt(0)
    v_smfmac_f32_16x16x64_bf16 v[64:67], v[28:31], v[192:199], v2
    v_smfmac_f32_16x16x64_bf16 v[68:71], v[28:31], v[200:207], v2
    v_smfmac_f32_16x16x64_bf16 v[72:75], v[28:31], v[208:215], v2
    v_smfmac_f32_16x16x64_bf16 v[76:79], v[28:31], v[216:223], v2
    v_smfmac_f32_16x16x64_bf16 v[80:83], v[28:31], v[224:231], v2
    v_smfmac_f32_16x16x64_bf16 v[84:87], v[28:31], v[232:239], v2
    v_smfmac_f32_16x16x64_bf16 v[88:91], v[28:31], v[240:247], v2
    v_smfmac_f32_16x16x64_bf16 v[92:95], v[28:31], v[248:255], v2
    s_add_u32 s4, s8, 0xb0000
    buffer_load_dwordx4 v[192:195], v1, s[44:47], s4 offen offset:0 sc1
    buffer_load_dwordx4 v[196:199], v1, s[44:47], s4 offen offset:1024 sc1
    buffer_load_dwordx4 v[200:203], v1, s[44:47], s4 offen offset:2048 sc1
    buffer_load_dwordx4 v[204:207], v1, s[44:47], s4 offen offset:3072 sc1
    s_add_u32 s4, s4, 4096
    buffer_load_dwordx4 v[208:211], v1, s[44:47], s4 offen offset:0 sc1
    buffer_load_dwordx4 v[212:215], v1, s[44:47], s4 offen offset:1024 sc1
    buffer_load_dwordx4 v[216:219], v1, s[44:47], s4 offen offset:2048 sc1
    buffer_load_dwordx4 v[220:223], v1, s[44:47], s4 offen offset:3072 sc1
    s_add_u32 s4, s4, 4096
    buffer_load_dwordx4 v[224:227], v1, s[44:47], s4 offen offset:0 sc1
    buffer_load_dwordx4 v[228:231], v1, s[44:47], s4 offen offset:1024 sc1
    buffer_load_dwordx4 v[232:235], v1, s[44:47], s4 offen offset:2048 sc1
    buffer_load_dwordx4 v[236:239], v1, s[44:47], s4 offen offset:3072 sc1
    s_add_u32 s4, s4, 4096
    buffer_load_dwordx4 v[240:243], v1, s[44:47], s4 offen offset:0 sc1
    buffer_load_dwordx4 v[244:247], v1, s[44:47], s4 offen offset:1024 sc1
    buffer_load_dwordx4 v[248:251], v1, s[44:47], s4 offen offset:2048 sc1
    buffer_load_dwordx4 v[252:255], v1, s[44:47], s4 offen offset:3072 sc1
    s_waitcnt lgkmcnt(0)
    s_barrier
    s_branch L_npoll_191x
L_npoll_191:
    s_sub_u32 s14, s14, 1
    s_cbranch_scc1 L_end_1
    s_sleep 0
L_npoll_191x:
    ds_read_b32 v24, v7 offset:9216
    s_waitcnt lgkmcnt(0)
    v_cmp_eq_f32 vcc, -1.0, v24
    s_cbranch_vccnz L_npoll_191
    ds_read2st64_b32 v[16:17], v6 offset0:36 offset1:37
    ds_read2st64_b32 v[18:19], v6 offset0:45 offset1:46
    ds_read2st64_b32 v[20:21], v6 offset0:54 offset1:55
    ds_read2st64_b32 v[22:23], v6 offset0:63 offset1:64
    ds_write_b32 v7, v96 offset:9216
    v_add_f32_dpp v24, v24, v24 quad_perm:[1,0,3,2] row_mask:0xf bank_mask:0xf
    s_nop 1
    v_add_f32_dpp v24, v24, v24 quad_perm:[2,3,0,1] row_mask:0xf bank_mask:0xf
    s_nop 0
    v_rcp_f32 v25, v24
    s_waitcnt lgkmcnt(3)
    v_add_f32 v16, v16, v18
    v_add_f32 v17, v17, v19
    s_waitcnt lgkmcnt(1)
    v_add_f32 v20, v20, v22
    v_add_f32 v21, v21, v23
    v_add_f32 v16, v16, v20
    v_add_f32 v17, v17, v21
    v_maximum3_f32 v12, |v16|, |v17|, v12
    v_mul_f32 v16, v16, v25
    v_mul_f32 v17, v17, v25
    v_maximum3_f32 v13, v24, v25, v13
    v_cvt_pk_bf16_f32 v16, v16, v17
    ds_write_b32 v8, v16 offset:384
    s_mov_b64 exec, 1
    ds_add_u32 v10, v9 offset:10508
    s_mov_b64 exec, -1
L_opoll_192:
    s_sub_u32 s14, s14, 1
    s_cbranch_scc1 L_end_1
    ds_read_b32 v16, v10 offset:10508
    ds_read_b128 v[28:31], v4 offset:384
    s_waitcnt lgkmcnt(0)
    v_cmp_ne_u32 vcc, 4, v16
    s_cbranch_vccnz L_opoll_192
    s_waitcnt vmcnt(0)
    v_smfmac_f32_16x16x64_bf16 v[64:67], v[28:31], v[192:199], v2
    v_smfmac_f32_16x16x64_bf16 v[68:71], v[28:31], v[200:207], v2
    v_smfmac_f32_16x16x64_bf16 v[72:75], v[28:31], v[208:215], v2
    v_smfmac_f32_16x16x64_bf16 v[76:79], v[28:31], v[216:223], v2
    v_smfmac_f32_16x16x64_bf16 v[80:83], v[28:31], v[224:231], v2
    v_smfmac_f32_16x16x64_bf16 v[84:87], v[28:31], v[232:239], v2
    v_smfmac_f32_16x16x64_bf16 v[88:91], v[28:31], v[240:247], v2
    v_smfmac_f32_16x16x64_bf16 v[92:95], v[28:31], v[248:255], v2
    s_add_u32 s4, s8, 0xc0000
    buffer_load_dwordx4 v[192:195], v1, s[44:47], s4 offen offset:0 sc1
    buffer_load_dwordx4 v[196:199], v1, s[44:47], s4 offen offset:1024 sc1
    buffer_load_dwordx4 v[200:203], v1, s[44:47], s4 offen offset:2048 sc1
    buffer_load_dwordx4 v[204:207], v1, s[44:47], s4 offen offset:3072 sc1
    s_add_u32 s4, s4, 4096
    buffer_load_dwordx4 v[208:211], v1, s[44:47], s4 offen offset:0 sc1
    buffer_load_dwordx4 v[212:215], v1, s[44:47], s4 offen offset:1024 sc1
    buffer_load_dwordx4 v[216:219], v1, s[44:47], s4 offen offset:2048 sc1
    buffer_load_dwordx4 v[220:223], v1, s[44:47], s4 offen offset:3072 sc1
    s_add_u32 s4, s4, 4096
    buffer_load_dwordx4 v[224:227], v1, s[44:47], s4 offen offset:0 sc1
    buffer_load_dwordx4 v[228:231], v1, s[44:47], s4 offen offset:1024 sc1
    buffer_load_dwordx4 v[232:235], v1, s[44:47], s4 offen offset:2048 sc1
    buffer_load_dwordx4 v[236:239], v1, s[44:47], s4 offen offset:3072 sc1
    s_add_u32 s4, s4, 4096
    buffer_load_dwordx4 v[240:243], v1, s[44:47], s4 offen offset:0 sc1
    buffer_load_dwordx4 v[244:247], v1, s[44:47], s4 offen offset:1024 sc1
    buffer_load_dwordx4 v[248:251], v1, s[44:47], s4 offen offset:2048 sc1
    buffer_load_dwordx4 v[252:255], v1, s[44:47], s4 offen offset:3072 sc1
    s_waitcnt lgkmcnt(0)
    s_barrier
    s_branch L_npoll_193x
L_npoll_193:
    s_sub_u32 s14, s14, 1
    s_cbranch_scc1 L_end_1
    s_sleep 0
L_npoll_193x:
    ds_read_b32 v24, v7 offset:0
    s_waitcnt lgkmcnt(0)
    v_cmp_eq_f32 vcc, -1.0, v24
    s_cbranch_vccnz L_npoll_193
    ds_read2st64_b32 v[16:17], v6 offset0:0 offset1:1
    ds_read2st64_b32 v[18:19], v6 offset0:9 offset1:10
    ds_read2st64_b32 v[20:21], v6 offset0:18 offset1:19
    ds_read2st64_b32 v[22:23], v6 offset0:27 offset1:28
    ds_write_b32 v7, v96 offset:0
    v_add_f32_dpp v24, v24, v24 quad_perm:[1,0,3,2] row_mask:0xf bank_mask:0xf
    s_nop 1
    v_add_f32_dpp v24, v24, v24 quad_perm:[2,3,0,1] row_mask:0xf bank_mask:0xf
    s_nop 0
    v_rcp_f32 v25, v24
    s_waitcnt lgkmcnt(3)
    v_add_f32 v16, v16, v18
    v_add_f32 v17, v17, v19
    s_waitcnt lgkmcnt(1)
    v_add_f32 v20, v20, v22
    v_add_f32 v21, v21, v23
    v_add_f32 v16, v16, v20
    v_add_f32 v17, v17, v21
    v_maximum3_f32 v12, |v16|, |v17|, v12
    v_mul_f32 v16, v16, v25
    v_mul_f32 v17, v17, v25
    v_maximum3_f32 v13, v24, v25, v13
    v_cvt_pk_bf16_f32 v16, v16, v17
    ds_write_b32 v8, v16 offset:512
    s_mov_b64 exec, 1
    ds_add_u32 v10, v9 offset:10512
    s_mov_b64 exec, -1
L_opoll_194:
    s_sub_u32 s14, s14, 1
    s_cbranch_scc1 L_end_1
    ds_read_b32 v16, v10 offset:10512
    ds_read_b128 v[28:31], v4 offset:512
    s_waitcnt lgkmcnt(0)
    v_cmp_ne_u32 vcc, 4, v16
    s_cbranch_vccnz L_opoll_194
    s_waitcnt vmcnt(0)
    v_smfmac_f32_16x16x64_bf16 v[64:67], v[28:31], v[192:199], v2
    v_smfmac_f32_16x16x64_bf16 v[68:71], v[28:31], v[200:207], v2
    v_smfmac_f32_16x16x64_bf16 v[72:75], v[28:31], v[208:215], v2
    v_smfmac_f32_16x16x64_bf16 v[76:79], v[28:31], v[216:223], v2
    v_smfmac_f32_16x16x64_bf16 v[80:83], v[28:31], v[224:231], v2
    v_smfmac_f32_16x16x64_bf16 v[84:87], v[28:31], v[232:239], v2
    v_smfmac_f32_16x16x64_bf16 v[88:91], v[28:31], v[240:247], v2
    v_smfmac_f32_16x16x64_bf16 v[92:95], v[28:31], v[248:255], v2
    s_add_u32 s4, s8, 0xd0000
    buffer_load_dwordx4 v[192:195], v1, s[44:47], s4 offen offset:0 sc1
    buffer_load_dwordx4 v[196:199], v1, s[44:47], s4 offen offset:1024 sc1
    buffer_load_dwordx4 v[200:203], v1, s[44:47], s4 offen offset:2048 sc1
    buffer_load_dwordx4 v[204:207], v1, s[44:47], s4 offen offset:3072 sc1
    s_add_u32 s4, s4, 4096
    buffer_load_dwordx4 v[208:211], v1, s[44:47], s4 offen offset:0 sc1
    buffer_load_dwordx4 v[212:215], v1, s[44:47], s4 offen offset:1024 sc1
    buffer_load_dwordx4 v[216:219], v1, s[44:47], s4 offen offset:2048 sc1
    buffer_load_dwordx4 v[220:223], v1, s[44:47], s4 offen offset:3072 sc1
    s_add_u32 s4, s4, 4096
    buffer_load_dwordx4 v[224:227], v1, s[44:47], s4 offen offset:0 sc1
    buffer_load_dwordx4 v[228:231], v1, s[44:47], s4 offen offset:1024 sc1
    buffer_load_dwordx4 v[232:235], v1, s[44:47], s4 offen offset:2048 sc1
    buffer_load_dwordx4 v[236:239], v1, s[44:47], s4 offen offset:3072 sc1
    s_add_u32 s4, s4, 4096
    buffer_load_dwordx4 v[240:243], v1, s[44:47], s4 offen offset:0 sc1
    buffer_load_dwordx4 v[244:247], v1, s[44:47], s4 offen offset:1024 sc1
    buffer_load_dwordx4 v[248:251], v1, s[44:47], s4 offen offset:2048 sc1
    buffer_load_dwordx4 v[252:255], v1, s[44:47], s4 offen offset:3072 sc1
    s_waitcnt lgkmcnt(0)
    s_barrier
    s_branch L_npoll_195x
L_npoll_195:
    s_sub_u32 s14, s14, 1
    s_cbranch_scc1 L_end_1
    s_sleep 0
L_npoll_195x:
    ds_read_b32 v24, v7 offset:9216
    s_waitcnt lgkmcnt(0)
    v_cmp_eq_f32 vcc, -1.0, v24
    s_cbranch_vccnz L_npoll_195
    ds_read2st64_b32 v[16:17], v6 offset0:36 offset1:37
    ds_read2st64_b32 v[18:19], v6 offset0:45 offset1:46
    ds_read2st64_b32 v[20:21], v6 offset0:54 offset1:55
    ds_read2st64_b32 v[22:23], v6 offset0:63 offset1:64
    ds_write_b32 v7, v96 offset:9216
    v_add_f32_dpp v24, v24, v24 quad_perm:[1,0,3,2] row_mask:0xf bank_mask:0xf
    s_nop 1
    v_add_f32_dpp v24, v24, v24 quad_perm:[2,3,0,1] row_mask:0xf bank_mask:0xf
    s_nop 0
    v_rcp_f32 v25, v24
    s_waitcnt lgkmcnt(3)
    v_add_f32 v16, v16, v18
    v_add_f32 v17, v17, v19
    s_waitcnt lgkmcnt(1)
    v_add_f32 v20, v20, v22
    v_add_f32 v21, v21, v23
    v_add_f32 v16, v16, v20
    v_add_f32 v17, v17, v21
    v_maximum3_f32 v12, |v16|, |v17|, v12
    v_mul_f32 v16, v16, v25
    v_mul_f32 v17, v17, v25
    v_maximum3_f32 v13, v24, v25, v13
    v_cvt_pk_bf16_f32 v16, v16, v17
    ds_write_b32 v8, v16 offset:640
    s_mov_b64 exec, 1
    ds_add_u32 v10, v9 offset:10516
    s_mov_b64 exec, -1
L_opoll_196:
    s_sub_u32 s14, s14, 1
    s_cbranch_scc1 L_end_1
    ds_read_b32 v16, v10 offset:10516
    ds_read_b128 v[28:31], v4 offset:640
    s_waitcnt lgkmcnt(0)
    v_cmp_ne_u32 vcc, 4, v16
    s_cbranch_vccnz L_opoll_196
    s_waitcnt vmcnt(0)
    v_smfmac_f32_16x16x64_bf16 v[64:67], v[28:31], v[192:199], v2
    v_smfmac_f32_16x16x64_bf16 v[68:71], v[28:31], v[200:207], v2
    v_smfmac_f32_16x16x64_bf16 v[72:75], v[28:31], v[208:215], v2
    v_smfmac_f32_16x16x64_bf16 v[76:79], v[28:31], v[216:223], v2
    v_smfmac_f32_16x16x64_bf16 v[80:83], v[28:31], v[224:231], v2
    v_smfmac_f32_16x16x64_bf16 v[84:87], v[28:31], v[232:239], v2
    v_smfmac_f32_16x16x64_bf16 v[88:91], v[28:31], v[240:247], v2
    v_smfmac_f32_16x16x64_bf16 v[92:95], v[28:31], v[248:255], v2
    s_add_u32 s4, s8, 0xe0000
    buffer_load_dwordx4 v[192:195], v1, s[44:47], s4 offen offset:0 sc1
    buffer_load_dwordx4 v[196:199], v1, s[44:47], s4 offen offset:1024 sc1
    buffer_load_dwordx4 v[200:203], v1, s[44:47], s4 offen offset:2048 sc1
    buffer_load_dwordx4 v[204:207], v1, s[44:47], s4 offen offset:3072 sc1
    s_add_u32 s4, s4, 4096
    buffer_load_dwordx4 v[208:211], v1, s[44:47], s4 offen offset:0 sc1
    buffer_load_dwordx4 v[212:215], v1, s[44:47], s4 offen offset:1024 sc1
    buffer_load_dwordx4 v[216:219], v1, s[44:47], s4 offen offset:2048 sc1
    buffer_load_dwordx4 v[220:223], v1, s[44:47], s4 offen offset:3072 sc1
    s_add_u32 s4, s4, 4096
    buffer_load_dwordx4 v[224:227], v1, s[44:47], s4 offen offset:0 sc1
    buffer_load_dwordx4 v[228:231], v1, s[44:47], s4 offen offset:1024 sc1
    buffer_load_dwordx4 v[232:235], v1, s[44:47], s4 offen offset:2048 sc1
    buffer_load_dwordx4 v[236:239], v1, s[44:47], s4 offen offset:3072 sc1
    s_add_u32 s4, s4, 4096
    buffer_load_dwordx4 v[240:243], v1, s[44:47], s4 offen offset:0 sc1
    buffer_load_dwordx4 v[244:247], v1, s[44:47], s4 offen offset:1024 sc1
    buffer_load_dwordx4 v[248:251], v1, s[44:47], s4 offen offset:2048 sc1
    buffer_load_dwordx4 v[252:255], v1, s[44:47], s4 offen offset:3072 sc1
    s_waitcnt lgkmcnt(0)
    s_barrier
    s_branch L_npoll_197x
L_npoll_197:
    s_sub_u32 s14, s14, 1
    s_cbranch_scc1 L_end_1
    s_sleep 0
L_npoll_197x:
    ds_read_b32 v24, v7 offset:0
    s_waitcnt lgkmcnt(0)
    v_cmp_eq_f32 vcc, -1.0, v24
    s_cbranch_vccnz L_npoll_197
    ds_read2st64_b32 v[16:17], v6 offset0:0 offset1:1
    ds_read2st64_b32 v[18:19], v6 offset0:9 offset1:10
    ds_read2st64_b32 v[20:21], v6 offset0:18 offset1:19
    ds_read2st64_b32 v[22:23], v6 offset0:27 offset1:28
    v_add_f32_dpp v24, v24, v24 quad_perm:[1,0,3,2] row_mask:0xf bank_mask:0xf
    s_nop 1
    v_add_f32_dpp v24, v24, v24 quad_perm:[2,3,0,1] row_mask:0xf bank_mask:0xf
    s_nop 0
    v_rcp_f32 v25, v24
    s_waitcnt lgkmcnt(2)
    v_add_f32 v16, v16, v18
    v_add_f32 v17, v17, v19
    s_waitcnt lgkmcnt(0)
    v_add_f32 v20, v20, v22
    v_add_f32 v21, v21, v23
    v_add_f32 v16, v16, v20
    v_add_f32 v17, v17, v21
    v_maximum3_f32 v12, |v16|, |v17|, v12
    v_mul_f32 v16, v16, v25
    v_mul_f32 v17, v17, v25
    v_maximum3_f32 v13, v24, v25, v13
    v_cvt_pk_bf16_f32 v16, v16, v17
    ds_write_b32 v8, v16 offset:768
    s_mov_b64 exec, 1
    ds_add_u32 v10, v9 offset:10520
    s_mov_b64 exec, -1
L_opoll_198:
    s_sub_u32 s14, s14, 1
    s_cbranch_scc1 L_end_1
    ds_read_b32 v16, v10 offset:10520
    ds_read_b128 v[28:31], v4 offset:768
    s_waitcnt lgkmcnt(0)
    v_cmp_ne_u32 vcc, 4, v16
    s_cbranch_vccnz L_opoll_198
    s_waitcnt vmcnt(0)
    v_smfmac_f32_16x16x64_bf16 v[64:67], v[28:31], v[192:199], v2
    v_smfmac_f32_16x16x64_bf16 v[68:71], v[28:31], v[200:207], v2
    v_smfmac_f32_16x16x64_bf16 v[72:75], v[28:31], v[208:215], v2
    v_smfmac_f32_16x16x64_bf16 v[76:79], v[28:31], v[216:223], v2
    v_smfmac_f32_16x16x64_bf16 v[80:83], v[28:31], v[224:231], v2
    v_smfmac_f32_16x16x64_bf16 v[84:87], v[28:31], v[232:239], v2
    v_smfmac_f32_16x16x64_bf16 v[88:91], v[28:31], v[240:247], v2
    v_smfmac_f32_16x16x64_bf16 v[92:95], v[28:31], v[248:255], v2
    s_add_u32 s4, s8, 0xf0000
    buffer_load_dwordx4 v[192:195], v1, s[44:47], s4 offen offset:0 sc1
    buffer_load_dwordx4 v[196:199], v1, s[44:47], s4 offen offset:1024 sc1
    buffer_load_dwordx4 v[200:203], v1, s[44:47], s4 offen offset:2048 sc1
    buffer_load_dwordx4 v[204:207], v1, s[44:47], s4 offen offset:3072 sc1
    s_add_u32 s4, s4, 4096
    buffer_load_dwordx4 v[208:211], v1, s[44:47], s4 offen offset:0 sc1
    buffer_load_dwordx4 v[212:215], v1, s[44:47], s4 offen offset:1024 sc1
    buffer_load_dwordx4 v[216:219], v1, s[44:47], s4 offen offset:2048 sc1
    buffer_load_dwordx4 v[220:223], v1, s[44:47], s4 offen offset:3072 sc1
    s_add_u32 s4, s4, 4096
    buffer_load_dwordx4 v[224:227], v1, s[44:47], s4 offen offset:0 sc1
    buffer_load_dwordx4 v[228:231], v1, s[44:47], s4 offen offset:1024 sc1
    buffer_load_dwordx4 v[232:235], v1, s[44:47], s4 offen offset:2048 sc1
    buffer_load_dwordx4 v[236:239], v1, s[44:47], s4 offen offset:3072 sc1
    s_add_u32 s4, s4, 4096
    buffer_load_dwordx4 v[240:243], v1, s[44:47], s4 offen offset:0 sc1
    buffer_load_dwordx4 v[244:247], v1, s[44:47], s4 offen offset:1024 sc1
    buffer_load_dwordx4 v[248:251], v1, s[44:47], s4 offen offset:2048 sc1
    buffer_load_dwordx4 v[252:255], v1, s[44:47], s4 offen offset:3072 sc1
    s_waitcnt lgkmcnt(0)
    s_barrier
    s_branch L_npoll_199x
L_npoll_199:
    s_sub_u32 s14, s14, 1
    s_cbranch_scc1 L_end_1
    s_sleep 0
L_npoll_199x:
    ds_read_b32 v24, v7 offset:9216
    s_waitcnt lgkmcnt(0)
    v_cmp_eq_f32 vcc, -1.0, v24
    s_cbranch_vccnz L_npoll_199
    ds_read2st64_b32 v[16:17], v6 offset0:36 offset1:37
    ds_read2st64_b32 v[18:19], v6 offset0:45 offset1:46
    ds_read2st64_b32 v[20:21], v6 offset0:54 offset1:55
    ds_read2st64_b32 v[22:23], v6 offset0:63 offset1:64
    v_add_f32_dpp v24, v24, v24 quad_perm:[1,0,3,2] row_mask:0xf bank_mask:0xf
    s_nop 1
    v_add_f32_dpp v24, v24, v24 quad_perm:[2,3,0,1] row_mask:0xf bank_mask:0xf
    s_nop 0
    v_rcp_f32 v25, v24
    s_waitcnt lgkmcnt(2)
    v_add_f32 v16, v16, v18
    v_add_f32 v17, v17, v19
    s_waitcnt lgkmcnt(0)
    v_add_f32 v20, v20, v22
    v_add_f32 v21, v21, v23
    v_add_f32 v16, v16, v20
    v_add_f32 v17, v17, v21
    v_maximum3_f32 v12, |v16|, |v17|, v12
    v_mul_f32 v16, v16, v25
    v_mul_f32 v17, v17, v25
    v_maximum3_f32 v13, v24, v25, v13
    v_cvt_pk_bf16_f32 v16, v16, v17
    ds_write_b32 v8, v16 offset:896
    s_mov_b64 exec, 1
    ds_add_u32 v10, v9 offset:10524
    s_mov_b64 exec, -1
L_opoll_200:
    s_sub_u32 s14, s14, 1
    s_cbranch_scc1 L_end_1
    ds_read_b32 v16, v10 offset:10524
    ds_read_b128 v[28:31], v4 offset:896
    s_waitcnt lgkmcnt(0)
    v_cmp_ne_u32 vcc, 4, v16
    s_cbranch_vccnz L_opoll_200
    s_waitcnt vmcnt(0)
    v_smfmac_f32_16x16x64_bf16 v[64:67], v[28:31], v[192:199], v2
    v_smfmac_f32_16x16x64_bf16 v[68:71], v[28:31], v[200:207], v2
    v_smfmac_f32_16x16x64_bf16 v[72:75], v[28:31], v[208:215], v2
    v_smfmac_f32_16x16x64_bf16 v[76:79], v[28:31], v[216:223], v2
    v_smfmac_f32_16x16x64_bf16 v[80:83], v[28:31], v[224:231], v2
    v_smfmac_f32_16x16x64_bf16 v[84:87], v[28:31], v[232:239], v2
    v_smfmac_f32_16x16x64_bf16 v[88:91], v[28:31], v[240:247], v2
    v_smfmac_f32_16x16x64_bf16 v[92:95], v[28:31], v[248:255], v2
    v_lshrrev_b32 v16, 4, v0
    v_mul_u32_u24 v16, 4160, v16
    v_and_b32 v17, 15, v0
    v_lshl_add_u32 v16, v17, 2, v16
    s_lshl_b32 s4, s9, 9
    s_add_u32 s4, s4, 37632
    v_add_u32 v16, s4, v16
    v_add_u32 v17, 2080, v16
    v_add_f32 v64, v64, v65
    v_add_f32 v66, v66, v67
    v_add_f32 v68, v68, v69
    v_add_f32 v70, v70, v71
    ds_write2_b32 v16, v64, v68 offset0:0 offset1:16
    ds_write2_b32 v17, v66, v70 offset0:0 offset1:16
    v_add_f32 v72, v72, v73
    v_add_f32 v74, v74, v75
    v_add_f32 v76, v76, v77
    v_add_f32 v78, v78, v79
    ds_write2_b32 v16, v72, v76 offset0:32 offset1:48
    ds_write2_b32 v17, v74, v78 offset0:32 offset1:48
    v_add_f32 v80, v80, v81
    v_add_f32 v82, v82, v83
    v_add_f32 v84, v84, v85
    v_add_f32 v86, v86, v87
    ds_write2_b32 v16, v80, v84 offset0:64 offset1:80
    ds_write2_b32 v17, v82, v86 offset0:64 offset1:80
    v_add_f32 v88, v88, v89
    v_add_f32 v90, v90, v91
    v_add_f32 v92, v92, v93
    v_add_f32 v94, v94, v95
    ds_write2_b32 v16, v88, v92 offset0:96 offset1:112
    ds_write2_b32 v17, v90, v94 offset0:96 offset1:112
    s_branch L_hepi_9
.section .rodata,"a"
.p2align 6
.amdhsa_kernel interleave_layers__grouped_kv_mqa__moe_arch_mod__prompt_kernel
  .amdhsa_next_free_vgpr 256
  .amdhsa_next_free_sgpr 102
  .amdhsa_accum_offset 256
  .amdhsa_group_segment_fixed_size 0
  .amdhsa_kernarg_size 104
  .amdhsa_user_sgpr_count 2
  .amdhsa_user_sgpr_kernarg_segment_ptr 1
  .amdhsa_system_sgpr_workgroup_id_x 1
.end_amdhsa_kernel
```
